```python
import torch

def _softmax(x, axis=-1):
    return torch.softmax(x, dim=axis)

def _gelu(x):
    return torch.nn.functional.gelu(x, approximate='tanh')

def _silu(x):
    return torch.nn.functional.silu(x)

def _sigmoid(x):
    return torch.sigmoid(x)

def _layernorm(x, axis=-1, eps=1e-05):
    m = x.mean(dim=axis, keepdim=True)
    v = x.var(dim=axis, keepdim=True, unbiased=False)
    return (x - m) / torch.sqrt(v + eps)

def _scatter_add(tgt, idx, src, axis=0):
    return tgt.clone().index_add_(axis, idx, src)

def _segment_sum(src, seg, n):
    out = torch.zeros((n,) + src.shape[1:], dtype=src.dtype)
    return out.index_add_(0, seg, src)

def _pad(x, pw):
    flat = tuple((v for pair in reversed(pw) for v in pair))
    return torch.nn.functional.pad(x, flat)
kernel_name = 'adaLN_cond__ssm_conv_h3__swiglu_ffn__prompt'

def setup_inputs():

    _w = lambda a: (lambda t: t.to(torch.bfloat16) if t.is_floating_point() else t)(torch.as_tensor(a))

    def _A_setup():
        B, S, D = (1, 2048, 512)
        ks = 4
        return {'q': _w((lambda *s: torch.randn(*s, dtype=torch.bfloat16) * 0.05)(B, S, D)), 'k': _w((lambda *s: torch.randn(*s, dtype=torch.bfloat16) * 0.8)(B, S, D)), 'v': _w((lambda *s: torch.randn(*s, dtype=torch.bfloat16) * 0.8)(B, S, D)), 'shift_k': _w((lambda *s: torch.randn(*s, dtype=torch.bfloat16) * 0.8)(D, ks) * 0.5), 'ssm_k': _w((lambda *s: torch.randn(*s, dtype=torch.bfloat16) * 0.8)(D, S) * (1.0 / S ** 0.5)), 'ssm_D': _w((lambda *s: torch.randn(*s, dtype=torch.bfloat16) * 0.8)(D))}
    _A_in = _A_setup()

    def _B_setup():
        B, S, D, F = (1, 2048, 512, 1792)
        return {'x': _w((lambda *s: torch.randn(*s, dtype=torch.bfloat16) * 0.05)(B, S, D)), 'w_gate': _w((lambda *s: torch.randn(*s, dtype=torch.bfloat16) * 0.05)(D, F)), 'w_up': _w((lambda *s: torch.randn(*s, dtype=torch.bfloat16) * 0.05)(D, F)), 'w_down': _w((lambda *s: torch.randn(*s, dtype=torch.bfloat16) * 0.05)(F, D))}
    _B_in = _B_setup()
    return {'A_q': _A_in['q'], 'A_k': _A_in['k'], 'A_v': _A_in['v'], 'A_shift_k': _A_in['shift_k'], 'A_ssm_k': _A_in['ssm_k'], 'A_ssm_D': _A_in['ssm_D'], 'B_x': _B_in['x'], 'B_w_gate': _B_in['w_gate'], 'B_w_up': _B_in['w_up'], 'B_w_down': _B_in['w_down'], 'c': _w((lambda *s: torch.randn(*s, dtype=torch.bfloat16) * 0.1)(1, 512) * 8.0), 'w_mod': _w((lambda *s: torch.randn(*s, dtype=torch.bfloat16) * 0.1)(512, 6 * 512) * 512 ** (-0.5) * 8.0)}

def reference(A_q, A_k, A_v, A_shift_k, A_ssm_k, A_ssm_D, B_x, B_w_gate, B_w_up, B_w_down, c, w_mod):

    def _A_ref(q, k, v, shift_k, ssm_k, ssm_D):
        B, S, D = q.shape
        ks = shift_k.shape[-1]
        k_pad = _pad(k, ((0, 0), (ks - 1, 0), (0, 0)))
        k_shift = torch.zeros_like(k)
        for t in range(ks):
            k_shift = k_shift + k_pad[:, t:t + S, :] * shift_k[:, ks - 1 - t][None, None, :]
        kv = k_shift * v
        L = 2 * S
        kv_pad = _pad(kv, ((0, 0), (0, S), (0, 0)))
        kf_pad = _pad(ssm_k, ((0, 0), (0, S)))
        kv_f = (lambda x, axes=(-2, -1): torch.fft.rfft2(x.float(), dim=axes))(kv_pad[:, None, :, :], axes=(1, 2))
        kf_f = (lambda x, axes=(-2, -1): torch.fft.rfft2(x.float(), dim=axes))(kf_pad[:, None, :], axes=(1, 2))
        kf_f = (lambda x, *d: x.permute(*d))(kf_f, 1, 2, 0)
        y_f = kv_f * kf_f[None, :, :, :]
        y = (lambda x, s, axes=(-2, -1): torch.fft.irfft2(x, s=s, dim=axes).to(torch.bfloat16))(y_f, (1, L), axes=(1, 2))[:, 0, :S, :]
        y = y + kv * ssm_D[None, None, :]
        return q * y

    def _B_ref(x, w_gate, w_up, w_down):
        g = _silu(x @ w_gate)
        u = x @ w_up
        return g * u @ w_down
    x = A_q
    mod = (_silu(c) @ w_mod).reshape(c.shape[0], 6, 1, -1)
    sa, ca, ga, sb, cb, gb = (mod[:, 0].clone(), mod[:, 1].clone(), mod[:, 2].clone(), mod[:, 3].clone(), mod[:, 4].clone(), mod[:, 5].clone())
    h = _layernorm(x, axis=-1) * (1 + ca) + sa
    x = x + ga * _A_ref(h, A_k, A_v, A_shift_k, A_ssm_k, A_ssm_D)
    h = _layernorm(x, axis=-1) * (1 + cb) + sb
    x = x + gb * _B_ref(h, B_w_gate, B_w_up, B_w_down)
    return x
```

```asm
; @launch grid=(256,1,1) block=(256,1,1) lds=163840
.amdgcn_target "amdgcn-amd-amdhsa--gfx950"
.text
.globl adaLN_cond__ssm_conv_h3__swiglu_ffn__prompt_kernel
.p2align 8
.type adaLN_cond__ssm_conv_h3__swiglu_ffn__prompt_kernel,@function
adaLN_cond__ssm_conv_h3__swiglu_ffn__prompt_kernel:
  s_cmp_ge_u32 s2, 256
  s_cbranch_scc1 K_END
  s_load_dwordx8 s[16:23], s[0:1], 0
  s_load_dwordx4 s[24:27], s[0:1], 32
  s_load_dwordx4 s[28:31], s[0:1], 56
  s_load_dwordx4 s[32:35], s[0:1], 72
  s_load_dwordx4 s[36:39], s[0:1], 88
  s_load_dwordx4 s[40:43], s[0:1], 104
  s_getpc_b64 s[60:61]
PC_HERE:
  v_lshlrev_b32 v3, 5, v0
  global_load_dword v253, v3, s[60:61]
  v_and_b32 v1, 63, v0
  v_lshrrev_b32 v2, 6, v0
  s_nop 0
  v_readfirstlane_b32 s3, v2
  s_and_b32 s44, s2, 7
  s_lshr_b32 s45, s2, 3
  s_lshl_b32 s46, s44, 5
  s_add_u32 s46, s46, s45
  s_waitcnt lgkmcnt(0)
  v_and_b32 v3, 7, v1
  v_lshrrev_b32 v4, 3, v1
  v_lshlrev_b32 v5, 10, v4
  v_lshl_add_u32 v5, v3, 4, v5
  s_lshl_b32 s56, s45, 16
  s_lshl_b32 s57, s44, 7
  s_add_u32 s56, s56, s57
  v_add_u32 v5, s56, v5
  s_mov_b32 s62, 4096
  s_mov_b32 s4, s18
  s_mov_b32 s5, s19
  s_mov_b32 s6, 0x200000
  s_mov_b32 s7, 0x20000
  s_mov_b32 s8, s20
  s_mov_b32 s9, s21
  s_mov_b32 s10, 0x200000
  s_mov_b32 s11, 0x20000
  s_lshl_b32 s57, s3, 13
  s_mul_i32 s58, s3, 1040
  s_add_u32 s59, s57, 32768
  s_add_u32 m0, s58, 52880
  s_nop 0
  buffer_load_dwordx4 v5, s[4:7], s57 offen lds
  s_add_u32 m0, s58, 61200
  s_nop 0
  buffer_load_dwordx4 v5, s[8:11], s57 offen lds
  s_add_u32 m0, s58, 57040
  s_nop 0
  buffer_load_dwordx4 v5, s[4:7], s59 offen lds
  s_add_u32 m0, s58, 65360
  s_nop 0
  buffer_load_dwordx4 v5, s[8:11], s59 offen lds
  s_cmp_lg_u32 s3, 3
  s_cbranch_scc1 P0_NOPRE
  v_subrev_u32 v6, 8192, v5
  v_mov_b32 v7, 0x40000000
  v_cmp_gt_u32 vcc, 8192, v5
  s_nop 1
  v_cndmask_b32 v6, v6, v7, vcc
  s_mov_b32 m0, 51840
  s_nop 0
  buffer_load_dwordx4 v6, s[4:7], 0 offen lds
P0_NOPRE:
  v_lshl_add_u32 v4, v2, 3, v4
  s_lshl_b32 s57, s44, 9
  v_lshlrev_b32 v7, 4, v4
  v_add_u32 v7, s57, v7
  s_mov_b32 s12, s22
  s_mov_b32 s13, s23
  s_mov_b32 s14, 0x1000
  s_mov_b32 s15, 0x20000
  buffer_load_dwordx4 v[32:35], v7, s[12:15], 0 offen
  v_mov_b32 v112, v4
  s_add_u32 s80, s42, 0x1100000
  s_addc_u32 s81, s43, 0
  s_mov_b32 s82, 0x5000
  s_mov_b32 s83, 0x20000
  s_cmp_lg_u32 s3, 0
  s_cbranch_scc1 PRO_NZ
  s_lshl_b32 s56, s44, 7
  s_lshl_b32 s57, s45, 2
  s_add_u32 s56, s56, s57
  s_lshr_b32 s58, s46, 4
  s_lshl_b32 s58, s58, 7
  s_and_b32 s57, s45, 15
  s_lshl_b32 s57, s57, 2
  s_add_u32 s58, s58, s57
  s_add_u32 s57, s58, 2048
  s_add_u32 s58, s58, 4096
  s_lshl_b32 s59, s46, 7
  s_add_u32 s59, s59, 8192
  s_cmp_lt_u32 s46, 64
  s_cselect_b32 s59, s59, 0x40000000
  v_mov_b32 v4, 0x40000000
  v_mov_b32 v5, 0
  v_writelane_b32 v4, s57, 1
  v_writelane_b32 v4, s58, 2
  v_writelane_b32 v4, s59, 3
  s_add_u32 s58, s58, 12288
  v_writelane_b32 v4, s58, 4
  buffer_store_dword v5, v4, s[80:83], 0 offen sc1
  s_lshl_b32 s57, s44, 7
  s_add_u32 s56, s57, 6144
  v_mov_b32 v110, s56
  s_add_u32 s56, s57, 1024
  v_writelane_b32 v110, s56, 1
  s_add_u32 s56, s57, 0
  v_writelane_b32 v110, s56, 2
  buffer_load_dword v111, v110, s[80:83], 0 offen sc1
  s_add_u32 s12, s42, 0xf80000
  s_addc_u32 s13, s43, 0
  s_mov_b32 s14, 0x3000
  s_mov_b32 s15, 0x20000
  s_lshl_b32 s56, s46, 8
  v_lshlrev_b32 v4, 2, v1
  v_add_u32 v4, s56, v4
  buffer_store_dword v5, v4, s[12:15], 0 offen sc1
PRO_NZ:
  s_cmp_lg_u32 s3, 1
  s_cbranch_scc1 PRO_NPF
  s_mul_i32 s56, s45, 11
  v_min_u32 v4, 10, v1
  v_add_u32 v4, s56, v4
  v_lshlrev_b32 v4, 7, v4
  v_min_u32 v4, K_CODE_END-PC_HERE-4, v4
  global_load_dword v254, v4, s[60:61]
PRO_NPF:
  v_mov_b32 v4, v112
  s_lshr_b32 s63, s3, 1
  s_and_b32 s64, s3, 1
  s_lshl_b32 s65, s44, 6
  s_lshl_b32 s66, s45, 1
  s_add_u32 s65, s65, s66
  s_add_u32 s66, s65, s63
  s_lshl_b32 s67, s65, 12
  s_add_u32 s52, s24, s67
  s_addc_u32 s53, s25, 0
  s_mov_b32 s54, 8192
  s_mov_b32 s55, 0x20000
  s_lshl_b32 s57, s63, 12
  v_lshrrev_b32 v37, 4, v1
  v_and_b32 v38, 15, v1
  v_add_u32 v39, v37, v38
  v_lshlrev_b32 v39, 2, v39
  v_subrev_u32 v40, 60, v39
  v_add_u32 v40, s57, v40
  v_mov_b32 v41, 0x40000000
  v_cmp_gt_u32 vcc, 60, v39
  s_nop 1
  v_cndmask_b32 v40, v40, v41, vcc
  v_lshlrev_b32 v123, 4, v1
  s_mul_i32 s72, s63, 16640
  s_mul_i32 s58, s64, 8320
  s_add_u32 s72, s72, s58
  s_lshl_b32 s73, s64, 3
  s_lshl_b32 s59, s63, 12
  s_add_u32 s73, s73, s59
  buffer_load_dword v120, v40, s[52:55], 0 offen
  v_mul_u32_u24 v37, 4160, v37
  v_lshl_add_u32 v37, v38, 2, v37
  s_mul_i32 s57, s63, 16640
  v_add_u32 v121, s57, v37
  s_mov_b32 s48, s26
  s_mov_b32 s49, s27
  s_mov_b32 s50, 0x400
  s_mov_b32 s51, 0x20000
  s_lshl_b32 s57, s66, 1
  v_mov_b32 v41, s57
  buffer_load_ushort v122, v41, s[48:51], 0 offen
  s_mov_b32 s48, s42
  s_mov_b32 s49, s43
  s_mov_b32 s50, 0x210000
  s_mov_b32 s51, 0x20000
  s_mul_i32 s57, s44, 270336
  s_add_u32 s57, s57, 4080
  s_lshl_b32 s58, s45, 7
  s_sub_u32 s57, s57, s58
  s_mov_b32 s74, 4224
  v_mul_u32_u24 v8, 8448, v4
  v_lshlrev_b32 v9, 4, v3
  v_sub_u32 v8, v8, v9
  v_add_u32 v8, s57, v8
  s_waitcnt vmcnt(0)
  s_barrier
  v_lshlrev_b32 v108, 7, v1
  s_cmp_eq_u32 s3, 1
  s_cselect_b32 s56, 0, 0x40000000
  v_add_u32 v108, s56, v108
  buffer_load_dword v140, v108, s[52:55], 0 offen
  s_cmp_lg_u32 s3, 0
  s_cbranch_scc1 ROOT_NR
  s_mov_b32 s12, s40
  s_mov_b32 s13, s41
  s_mov_b32 s14, 0x100
  s_mov_b32 s15, 0x20000
  s_and_b32 s56, s46, 7
  s_lshl_b32 s56, s56, 2
  s_add_u32 s56, s56, 160
  s_cmp_lt_u32 s46, 64
  s_cselect_b32 s56, s56, 0x40000000
  v_mov_b32 v108, 0x40000000
  v_mov_b32 v109, 1
  v_writelane_b32 v108, s56, 0
  buffer_atomic_add v109, v108, s[12:15], 0 offen sc1
  v_readfirstlane_b32 s97, v111
  s_nop 3
  s_mul_i32 s97, s97, 0x9e3779b1
  s_add_u32 s97, s97, 0x7f4a7c15
ROOT_NR:
  v_mul_u32_u24 v9, 1040, v3
  v_lshl_add_u32 v9, v4, 2, v9
  v_add_u32 v9, 51840, v9
  ds_read_b32 v10, v9 offset:640
  ds_read_b32 v11, v9 offset:768
  ds_read_b32 v12, v9 offset:896
  ds_read_b32 v13, v9 offset:1040
  ds_read_b32 v14, v9 offset:1168
  ds_read_b32 v15, v9 offset:1296
  ds_read_b32 v16, v9 offset:1424
  ds_read_b32 v17, v9 offset:1552
  ds_read_b32 v18, v9 offset:1680
  ds_read_b32 v19, v9 offset:1808
  ds_read_b32 v20, v9 offset:1936
  ds_read_b32 v22, v9 offset:9360
  ds_read_b32 v23, v9 offset:9488
  ds_read_b32 v24, v9 offset:9616
  ds_read_b32 v25, v9 offset:9744
  ds_read_b32 v26, v9 offset:9872
  ds_read_b32 v27, v9 offset:10000
  ds_read_b32 v28, v9 offset:10128
  ds_read_b32 v29, v9 offset:10256
  v_lshlrev_b32 v36, 16, v32
  v_lshlrev_b32 v37, 16, v34
  v_and_b32 v38, 0xffff0000, v32
  v_and_b32 v39, 0xffff0000, v34
  v_lshlrev_b32 v40, 16, v33
  v_lshlrev_b32 v41, 16, v35
  v_and_b32 v42, 0xffff0000, v33
  v_and_b32 v43, 0xffff0000, v35
  s_waitcnt lgkmcnt(0)
  v_lshlrev_b32 v44, 16, v10
  v_and_b32 v45, 0xffff0000, v10
  v_lshlrev_b32 v46, 16, v11
  v_and_b32 v47, 0xffff0000, v11
  v_lshlrev_b32 v48, 16, v12
  v_and_b32 v49, 0xffff0000, v12
  v_lshlrev_b32 v50, 16, v13
  v_and_b32 v51, 0xffff0000, v13
  v_lshlrev_b32 v52, 16, v14
  v_and_b32 v53, 0xffff0000, v14
  v_lshlrev_b32 v54, 16, v15
  v_and_b32 v55, 0xffff0000, v15
  v_lshlrev_b32 v56, 16, v16
  v_and_b32 v57, 0xffff0000, v16
  v_lshlrev_b32 v58, 16, v17
  v_and_b32 v59, 0xffff0000, v17
  v_lshlrev_b32 v60, 16, v18
  v_and_b32 v61, 0xffff0000, v18
  v_lshlrev_b32 v62, 16, v19
  v_and_b32 v63, 0xffff0000, v19
  v_lshlrev_b32 v64, 16, v20
  v_and_b32 v65, 0xffff0000, v20
  v_pk_mul_f32 v[84:85], v[44:45], v[42:43]
  v_pk_mul_f32 v[86:87], v[46:47], v[42:43]
  v_pk_mul_f32 v[88:89], v[48:49], v[42:43]
  v_pk_mul_f32 v[90:91], v[50:51], v[42:43]
  v_pk_mul_f32 v[92:93], v[52:53], v[42:43]
  v_pk_mul_f32 v[94:95], v[54:55], v[42:43]
  v_pk_mul_f32 v[96:97], v[56:57], v[42:43]
  v_pk_mul_f32 v[98:99], v[58:59], v[42:43]
  v_lshlrev_b32 v66, 16, v22
  v_and_b32 v67, 0xffff0000, v22
  v_lshlrev_b32 v68, 16, v23
  v_and_b32 v69, 0xffff0000, v23
  v_lshlrev_b32 v70, 16, v24
  v_and_b32 v71, 0xffff0000, v24
  v_lshlrev_b32 v72, 16, v25
  v_and_b32 v73, 0xffff0000, v25
  v_lshlrev_b32 v74, 16, v26
  v_and_b32 v75, 0xffff0000, v26
  v_lshlrev_b32 v76, 16, v27
  v_and_b32 v77, 0xffff0000, v27
  v_lshlrev_b32 v78, 16, v28
  v_and_b32 v79, 0xffff0000, v28
  v_lshlrev_b32 v80, 16, v29
  v_and_b32 v81, 0xffff0000, v29
  v_cvt_pk_bf16_f32 v84, 0, v84
  v_cvt_pk_bf16_f32 v85, 0, v85
  v_cvt_pk_bf16_f32 v86, 0, v86
  v_cvt_pk_bf16_f32 v87, 0, v87
  v_cvt_pk_bf16_f32 v88, 0, v88
  v_cvt_pk_bf16_f32 v89, 0, v89
  v_cvt_pk_bf16_f32 v90, 0, v90
  v_cvt_pk_bf16_f32 v91, 0, v91
  v_cvt_pk_bf16_f32 v92, 0, v92
  v_cvt_pk_bf16_f32 v93, 0, v93
  v_cvt_pk_bf16_f32 v94, 0, v94
  v_cvt_pk_bf16_f32 v95, 0, v95
  v_cvt_pk_bf16_f32 v96, 0, v96
  v_cvt_pk_bf16_f32 v97, 0, v97
  v_cvt_pk_bf16_f32 v98, 0, v98
  v_cvt_pk_bf16_f32 v99, 0, v99
  v_pk_mul_f32 v[100:101], v[46:47], v[40:41]
  v_pk_mul_f32 v[102:103], v[48:49], v[40:41]
  v_pk_mul_f32 v[104:105], v[50:51], v[40:41]
  v_pk_mul_f32 v[106:107], v[52:53], v[40:41]
  v_pk_mul_f32 v[108:109], v[54:55], v[40:41]
  v_pk_mul_f32 v[110:111], v[56:57], v[40:41]
  v_pk_mul_f32 v[112:113], v[58:59], v[40:41]
  v_pk_mul_f32 v[114:115], v[60:61], v[40:41]
  v_cvt_pk_bf16_f32 v100, 0, v100
  v_cvt_pk_bf16_f32 v101, 0, v101
  v_cvt_pk_bf16_f32 v102, 0, v102
  v_cvt_pk_bf16_f32 v103, 0, v103
  v_cvt_pk_bf16_f32 v104, 0, v104
  v_cvt_pk_bf16_f32 v105, 0, v105
  v_cvt_pk_bf16_f32 v106, 0, v106
  v_cvt_pk_bf16_f32 v107, 0, v107
  v_cvt_pk_bf16_f32 v108, 0, v108
  v_cvt_pk_bf16_f32 v109, 0, v109
  v_cvt_pk_bf16_f32 v110, 0, v110
  v_cvt_pk_bf16_f32 v111, 0, v111
  v_cvt_pk_bf16_f32 v112, 0, v112
  v_cvt_pk_bf16_f32 v113, 0, v113
  v_cvt_pk_bf16_f32 v114, 0, v114
  v_cvt_pk_bf16_f32 v115, 0, v115
  v_pk_add_f32 v[84:85], v[84:85], v[100:101]
  v_pk_add_f32 v[86:87], v[86:87], v[102:103]
  v_pk_add_f32 v[88:89], v[88:89], v[104:105]
  v_pk_add_f32 v[90:91], v[90:91], v[106:107]
  v_pk_add_f32 v[92:93], v[92:93], v[108:109]
  v_pk_add_f32 v[94:95], v[94:95], v[110:111]
  v_pk_add_f32 v[96:97], v[96:97], v[112:113]
  v_pk_add_f32 v[98:99], v[98:99], v[114:115]
  v_cvt_pk_bf16_f32 v84, 0, v84
  v_cvt_pk_bf16_f32 v85, 0, v85
  v_cvt_pk_bf16_f32 v86, 0, v86
  v_cvt_pk_bf16_f32 v87, 0, v87
  v_cvt_pk_bf16_f32 v88, 0, v88
  v_cvt_pk_bf16_f32 v89, 0, v89
  v_cvt_pk_bf16_f32 v90, 0, v90
  v_cvt_pk_bf16_f32 v91, 0, v91
  v_cvt_pk_bf16_f32 v92, 0, v92
  v_cvt_pk_bf16_f32 v93, 0, v93
  v_cvt_pk_bf16_f32 v94, 0, v94
  v_cvt_pk_bf16_f32 v95, 0, v95
  v_cvt_pk_bf16_f32 v96, 0, v96
  v_cvt_pk_bf16_f32 v97, 0, v97
  v_cvt_pk_bf16_f32 v98, 0, v98
  v_cvt_pk_bf16_f32 v99, 0, v99
  v_pk_mul_f32 v[100:101], v[48:49], v[38:39]
  v_pk_mul_f32 v[102:103], v[50:51], v[38:39]
  v_pk_mul_f32 v[104:105], v[52:53], v[38:39]
  v_pk_mul_f32 v[106:107], v[54:55], v[38:39]
  v_pk_mul_f32 v[108:109], v[56:57], v[38:39]
  v_pk_mul_f32 v[110:111], v[58:59], v[38:39]
  v_pk_mul_f32 v[112:113], v[60:61], v[38:39]
  v_pk_mul_f32 v[114:115], v[62:63], v[38:39]
  v_cvt_pk_bf16_f32 v100, 0, v100
  v_cvt_pk_bf16_f32 v101, 0, v101
  v_cvt_pk_bf16_f32 v102, 0, v102
  v_cvt_pk_bf16_f32 v103, 0, v103
  v_cvt_pk_bf16_f32 v104, 0, v104
  v_cvt_pk_bf16_f32 v105, 0, v105
  v_cvt_pk_bf16_f32 v106, 0, v106
  v_cvt_pk_bf16_f32 v107, 0, v107
  v_cvt_pk_bf16_f32 v108, 0, v108
  v_cvt_pk_bf16_f32 v109, 0, v109
  v_cvt_pk_bf16_f32 v110, 0, v110
  v_cvt_pk_bf16_f32 v111, 0, v111
  v_cvt_pk_bf16_f32 v112, 0, v112
  v_cvt_pk_bf16_f32 v113, 0, v113
  v_cvt_pk_bf16_f32 v114, 0, v114
  v_cvt_pk_bf16_f32 v115, 0, v115
  v_pk_add_f32 v[84:85], v[84:85], v[100:101]
  v_pk_add_f32 v[86:87], v[86:87], v[102:103]
  v_pk_add_f32 v[88:89], v[88:89], v[104:105]
  v_pk_add_f32 v[90:91], v[90:91], v[106:107]
  v_pk_add_f32 v[92:93], v[92:93], v[108:109]
  v_pk_add_f32 v[94:95], v[94:95], v[110:111]
  v_pk_add_f32 v[96:97], v[96:97], v[112:113]
  v_pk_add_f32 v[98:99], v[98:99], v[114:115]
  v_cvt_pk_bf16_f32 v84, 0, v84
  v_cvt_pk_bf16_f32 v85, 0, v85
  v_cvt_pk_bf16_f32 v86, 0, v86
  v_cvt_pk_bf16_f32 v87, 0, v87
  v_cvt_pk_bf16_f32 v88, 0, v88
  v_cvt_pk_bf16_f32 v89, 0, v89
  v_cvt_pk_bf16_f32 v90, 0, v90
  v_cvt_pk_bf16_f32 v91, 0, v91
  v_cvt_pk_bf16_f32 v92, 0, v92
  v_cvt_pk_bf16_f32 v93, 0, v93
  v_cvt_pk_bf16_f32 v94, 0, v94
  v_cvt_pk_bf16_f32 v95, 0, v95
  v_cvt_pk_bf16_f32 v96, 0, v96
  v_cvt_pk_bf16_f32 v97, 0, v97
  v_cvt_pk_bf16_f32 v98, 0, v98
  v_cvt_pk_bf16_f32 v99, 0, v99
  v_pk_mul_f32 v[100:101], v[50:51], v[36:37]
  v_pk_mul_f32 v[102:103], v[52:53], v[36:37]
  v_pk_mul_f32 v[104:105], v[54:55], v[36:37]
  v_pk_mul_f32 v[106:107], v[56:57], v[36:37]
  v_pk_mul_f32 v[108:109], v[58:59], v[36:37]
  v_pk_mul_f32 v[110:111], v[60:61], v[36:37]
  v_pk_mul_f32 v[112:113], v[62:63], v[36:37]
  v_pk_mul_f32 v[114:115], v[64:65], v[36:37]
  v_cvt_pk_bf16_f32 v100, 0, v100
  v_cvt_pk_bf16_f32 v101, 0, v101
  v_cvt_pk_bf16_f32 v102, 0, v102
  v_cvt_pk_bf16_f32 v103, 0, v103
  v_cvt_pk_bf16_f32 v104, 0, v104
  v_cvt_pk_bf16_f32 v105, 0, v105
  v_cvt_pk_bf16_f32 v106, 0, v106
  v_cvt_pk_bf16_f32 v107, 0, v107
  v_cvt_pk_bf16_f32 v108, 0, v108
  v_cvt_pk_bf16_f32 v109, 0, v109
  v_cvt_pk_bf16_f32 v110, 0, v110
  v_cvt_pk_bf16_f32 v111, 0, v111
  v_cvt_pk_bf16_f32 v112, 0, v112
  v_cvt_pk_bf16_f32 v113, 0, v113
  v_cvt_pk_bf16_f32 v114, 0, v114
  v_cvt_pk_bf16_f32 v115, 0, v115
  v_pk_add_f32 v[84:85], v[84:85], v[100:101]
  v_pk_add_f32 v[86:87], v[86:87], v[102:103]
  v_pk_add_f32 v[88:89], v[88:89], v[104:105]
  v_pk_add_f32 v[90:91], v[90:91], v[106:107]
  v_pk_add_f32 v[92:93], v[92:93], v[108:109]
  v_pk_add_f32 v[94:95], v[94:95], v[110:111]
  v_pk_add_f32 v[96:97], v[96:97], v[112:113]
  v_pk_add_f32 v[98:99], v[98:99], v[114:115]
  v_cvt_pk_bf16_f32 v84, 0, v84
  v_cvt_pk_bf16_f32 v85, 0, v85
  v_cvt_pk_bf16_f32 v86, 0, v86
  v_cvt_pk_bf16_f32 v87, 0, v87
  v_cvt_pk_bf16_f32 v88, 0, v88
  v_cvt_pk_bf16_f32 v89, 0, v89
  v_cvt_pk_bf16_f32 v90, 0, v90
  v_cvt_pk_bf16_f32 v91, 0, v91
  v_cvt_pk_bf16_f32 v92, 0, v92
  v_cvt_pk_bf16_f32 v93, 0, v93
  v_cvt_pk_bf16_f32 v94, 0, v94
  v_cvt_pk_bf16_f32 v95, 0, v95
  v_cvt_pk_bf16_f32 v96, 0, v96
  v_cvt_pk_bf16_f32 v97, 0, v97
  v_cvt_pk_bf16_f32 v98, 0, v98
  v_cvt_pk_bf16_f32 v99, 0, v99
  v_pk_mul_f32 v[84:85], v[84:85], v[66:67]
  v_pk_mul_f32 v[86:87], v[86:87], v[68:69]
  v_pk_mul_f32 v[88:89], v[88:89], v[70:71]
  v_pk_mul_f32 v[90:91], v[90:91], v[72:73]
  v_pk_mul_f32 v[92:93], v[92:93], v[74:75]
  v_pk_mul_f32 v[94:95], v[94:95], v[76:77]
  v_pk_mul_f32 v[96:97], v[96:97], v[78:79]
  v_pk_mul_f32 v[98:99], v[98:99], v[80:81]
  v_cvt_pk_bf16_f32 v128, v98, v96
  v_cvt_pk_bf16_f32 v129, v94, v92
  v_cvt_pk_bf16_f32 v130, v90, v88
  v_cvt_pk_bf16_f32 v131, v86, v84
  v_cvt_pk_bf16_f32 v132, v99, v97
  v_cvt_pk_bf16_f32 v133, v95, v93
  v_cvt_pk_bf16_f32 v134, v91, v89
  v_cvt_pk_bf16_f32 v135, v87, v85
  buffer_store_dwordx4 v[128:131], v8, s[48:51], 0 offen sc1
  buffer_store_dwordx4 v[132:135], v8, s[48:51], s74 offen sc1
  s_add_u32 m0, s72, 64
  s_add_u32 s59, s73, 4
  buffer_load_dwordx4 v123, s[52:55], s59 offen lds
  s_add_u32 m0, s72, 1088
  s_add_u32 s59, s73, 1028
  buffer_load_dwordx4 v123, s[52:55], s59 offen lds
  s_add_u32 m0, s72, 2112
  s_add_u32 s59, s73, 2052
  buffer_load_dwordx4 v123, s[52:55], s59 offen lds
  s_add_u32 m0, s72, 3136
  s_add_u32 s59, s73, 3076
  buffer_load_dwordx4 v123, s[52:55], s59 offen lds
  s_add_u32 m0, s72, 4224
  s_add_u32 s59, s73, 8
  buffer_load_dwordx4 v123, s[52:55], s59 offen lds
  s_add_u32 m0, s72, 5248
  s_add_u32 s59, s73, 1032
  buffer_load_dwordx4 v123, s[52:55], s59 offen lds
  s_add_u32 m0, s72, 6272
  s_add_u32 s59, s73, 2056
  buffer_load_dwordx4 v123, s[52:55], s59 offen lds
  s_add_u32 m0, s72, 7296
  s_add_u32 s59, s73, 3080
  buffer_load_dwordx4 v123, s[52:55], s59 offen lds
  ds_write_b32 v121, v120
  v_mov_b32 v32, 0
  v_mov_b32 v33, 0
  v_mov_b32 v34, 0
  v_mov_b32 v35, 0
  v_mul_u32_u24 v17, 2341, v0
  v_lshrrev_b32 v17, 16, v17
  v_mul_u32_u24 v18, 28, v17
  v_sub_u32 v18, v0, v18
  v_mul_u32_u24 v17, 4640, v17
  v_lshl_add_u32 v17, v18, 4, v17
  v_add_u32 v17, 37376, v17
  v_cmp_gt_u32 vcc, 112, v0
  s_nop 3
  s_and_saveexec_b64 s[58:59], vcc
  ds_write_b128 v17, v[32:35]
  s_mov_b64 exec, s[58:59]
  s_waitcnt vmcnt(8)
  s_barrier
  s_mov_b32 s76, s32
  s_mov_b32 s77, s33
  s_mul_i32 s56, s46, 7168
  s_mov_b32 s57, 0x40000000
  s_cmp_eq_u32 s3, 3
  s_cselect_b32 s76, s32, s76
  s_cselect_b32 s77, s33, s77
  s_cselect_b32 s57, s56, s57
  s_mov_b32 s78, 1835008
  s_mov_b32 s79, 0x20000
  v_lshlrev_b32 v226, 7, v1
  v_add_u32 v226, s57, v226
  v_mov_b32 v227, 0x40000000
  v_cmp_gt_u32 vcc, 56, v1
  s_nop 1
  v_cndmask_b32 v226, v227, v226, vcc
  buffer_load_dword v228, v226, s[76:79], 0 offen
  s_cmp_lg_u32 s3, 0
  s_cbranch_scc1 X1_SKIP
  s_lshl_b32 s57, s44, 7
  s_lshl_b32 s58, s45, 2
  s_add_u32 s58, s57, s58
  s_add_u32 s59, s58, 1024
  v_mov_b32 v4, 0x40000000
  v_mov_b32 v5, s97
  v_mov_b32 v6, 0x40000000
  v_writelane_b32 v4, s58, 0
  v_writelane_b32 v6, s59, 0
  buffer_store_dword v5, v6, s[80:83], 0 offen
  buffer_store_dword v5, v4, s[80:83], 0 offen sc1
  v_and_b32 v6, 31, v1
  v_lshlrev_b32 v6, 2, v6
  v_add_u32 v6, s57, v6
  v_add_u32 v8, 1024, v6
  s_mov_b32 s56, 0
  s_mov_b64 s[58:59], 0
POLL1:
  buffer_load_dword v4, v8, s[80:83], 0 offen sc1
  s_waitcnt vmcnt(0)
  v_cmp_eq_u32 vcc, s97, v4
  s_nop 3
  s_or_b64 s[58:59], s[58:59], vcc
  s_cmp_eq_u64 s[58:59], -1
  s_cbranch_scc1 POLLD2
  s_add_u32 s56, s56, 1
  s_and_b32 s57, s56, 7
  s_cbranch_scc1 POLL1
  buffer_load_dword v4, v6, s[80:83], 0 offen sc1
  s_waitcnt vmcnt(0)
  v_cmp_eq_u32 vcc, s97, v4
  s_nop 3
  s_or_b64 s[58:59], s[58:59], vcc
  s_cmp_eq_u64 s[58:59], -1
  s_cbranch_scc1 POLLD2
  s_cmp_lt_u32 s56, 400000
  s_cbranch_scc1 POLL1
POLLD2:
X1_SKIP:
  s_barrier
  s_mov_b32 s8, s42
  s_mov_b32 s9, s43
  s_mov_b32 s10, 0x1000
  s_mov_b32 s11, 0x20000
  s_mul_i32 s57, s65, 4224
  s_add_u32 s8, s8, s57
  s_addc_u32 s9, s9, 0
  s_add_u32 s12, s8, 4224
  s_addc_u32 s13, s9, 0
  s_mov_b32 s14, 4096
  s_mov_b32 s15, 0x20000
  v_lshlrev_b32 v10, 4, v0
  buffer_load_dwordx4 v[12:15], v10, s[8:11], 0 offen sc1
  buffer_load_dword v16, v10, s[8:11], 0 offen offset:16 sc1
  buffer_load_dwordx4 v[20:23], v10, s[12:15], 0 offen sc1
  buffer_load_dword v24, v10, s[12:15], 0 offen offset:16 sc1
  s_mov_b32 s4, s16
  s_mov_b32 s5, s17
  s_mov_b32 s6, 0x200000
  s_mov_b32 s7, 0x20000
  s_mov_b32 s48, s36
  s_mov_b32 s49, s37
  s_mov_b32 s50, 0x300000
  s_mov_b32 s51, 0x20000
  s_mov_b32 s52, s34
  s_mov_b32 s53, s35
  s_mov_b32 s54, 0x400
  s_mov_b32 s55, 0x20000
  s_lshl_b32 s57, s46, 13
  v_lshlrev_b32 v209, 2, v0
  v_add_u32 v209, s57, v209
  s_mul_i32 s68, s46, 1366
  s_lshr_b32 s68, s68, 16
  s_mul_i32 s69, s68, 48
  s_sub_u32 s69, s46, s69
  s_lshl_b32 s57, s68, 7
  s_lshl_b32 s58, s3, 5
  s_add_u32 s57, s57, s58
  v_lshrrev_b32 v30, 3, v1
  v_add_u32 v30, s57, v30
  v_lshlrev_b32 v31, 1, v30
  v_mul_u32_u24 v30, 6144, v30
  v_and_b32 v8, 7, v1
  v_lshl_add_u32 v30, v8, 4, v30
  s_lshl_b32 s57, s69, 7
  v_add_u32 v30, s57, v30
  s_mov_b32 s60, 0
  buffer_load_dwordx4 v[192:195], v30, s[48:51], s60 offen
  s_mov_b32 s60, 49152
  buffer_load_dwordx4 v[196:199], v30, s[48:51], s60 offen
  s_mov_b32 s60, 98304
  buffer_load_dwordx4 v[200:203], v30, s[48:51], s60 offen
  s_mov_b32 s60, 147456
  buffer_load_dwordx4 v[204:207], v30, s[48:51], s60 offen
  buffer_load_ushort v220, v31, s[52:55], 0 offen offset:0
  buffer_load_ushort v221, v31, s[52:55], 0 offen offset:16
  buffer_load_ushort v222, v31, s[52:55], 0 offen offset:32
  buffer_load_ushort v223, v31, s[52:55], 0 offen offset:48
  s_lshl_b32 s75, s69, 8
  s_cmp_lt_u32 s46, 192
  s_cselect_b32 s75, s75, 0x40000000
  s_cmp_lt_u32 s3, 2
  s_cselect_b32 s76, s28, s30
  s_cselect_b32 s77, s29, s31
  s_mov_b32 s78, 1835008
  s_mov_b32 s79, 0x20000
  s_lshl_b32 s57, s45, 4
  s_and_b32 s58, s3, 1
  s_lshl_b32 s58, s58, 3
  s_add_u32 s57, s57, s58
  s_and_b32 s58, s44, 3
  s_lshl_b32 s59, s58, 9
  s_mul_i32 s58, s58, 384
  s_add_u32 s58, s58, 1536
  v_mul_u32_u24 v226, 9363, v1
  v_lshrrev_b32 v226, 16, v226
  v_mul_u32_u24 v227, 7, v226
  v_sub_u32 v227, v1, v227
  v_add_u32 v226, s57, v226
  v_mul_u32_u24 v226, 3584, v226
  v_lshl_add_u32 v226, v227, 7, v226
  v_mov_b32 v229, s59
  v_mov_b32 v230, s58
  v_cmp_gt_u32 vcc, 4, v227
  s_nop 1
  v_cndmask_b32 v229, v230, v229, vcc
  v_add_u32 v226, v226, v229
  v_mov_b32 v227, 0x40000000
  v_cmp_gt_u32 vcc, 56, v1
  s_nop 1
  v_cndmask_b32 v226, v227, v226, vcc
  s_waitcnt vmcnt(8)
  v_add_u32 v17, 33280, v10
  v_alignbit_b32 v32, v13, v12, 16
  v_alignbit_b32 v33, v14, v13, 16
  v_alignbit_b32 v34, v15, v14, 16
  v_alignbit_b32 v35, v16, v15, 16
  ds_write_b128 v17, v[32:35] offset:0
  ds_write_b128 v17, v[12:15] offset:4640
  v_alignbit_b32 v36, v21, v20, 16
  v_alignbit_b32 v37, v22, v21, 16
  v_alignbit_b32 v38, v23, v22, 16
  v_alignbit_b32 v39, v24, v23, 16
  ds_write_b128 v17, v[36:39] offset:9280
  ds_write_b128 v17, v[20:23] offset:13920
  v_lshlrev_b32 v25, 16, v122
  v_and_b32 v4, 15, v1
  v_lshrrev_b32 v5, 4, v1
  v_and_b32 v6, 3, v4
  v_mul_u32_u24 v6, 4160, v6
  v_lshrrev_b32 v7, 2, v4
  v_add_u32 v7, v7, v5
  v_lshl_add_u32 v6, v7, 4, v6
  s_mul_i32 s57, s63, 16640
  s_lshl_b32 s58, s64, 8
  s_add_u32 s57, s57, s58
  v_add_u32 v6, s57, v6
  v_and_b32 v7, 1, v4
  v_mul_u32_u24 v7, 4640, v7
  v_lshrrev_b32 v8, 1, v4
  v_lshlrev_b32 v8, 6, v8
  v_sub_u32 v7, v7, v8
  v_lshl_add_u32 v7, v5, 4, v7
  s_mul_i32 s57, s63, 9280
  s_add_u32 s57, s57, 33728
  s_add_u32 s57, s57, s58
  v_add_u32 v7, s57, v7
  s_mov_b32 s12, s40
  s_mov_b32 s13, s41
  s_mov_b32 s14, 0x100
  s_mov_b32 s15, 0x20000
  v_and_b32 v224, 7, v1
  v_lshlrev_b32 v224, 2, v224
  v_add_u32 v224, 160, v224
  s_cmp_eq_u32 s3, 0
  s_cselect_b32 s57, 0, 0x40000000
  v_add_u32 v224, s57, v224
  buffer_load_dword v225, v224, s[12:15], 0 offen sc1
  s_waitcnt lgkmcnt(0)
  s_barrier
  ds_read_b128 v[96:99], v7 offset:3584
  ds_read_b128 v[32:35], v6 offset:0
  ds_read_b128 v[100:103], v7 offset:3072
  ds_read_b128 v[36:39], v6 offset:512
  ds_read_b128 v[104:107], v7 offset:2560
  ds_read_b128 v[40:43], v6 offset:1024
  ds_read_b128 v[108:111], v7 offset:2048
  ds_read_b128 v[44:47], v6 offset:1536
  ds_read_b128 v[112:115], v7 offset:1536
  ds_read_b128 v[48:51], v6 offset:2048
  ds_read_b128 v[116:119], v7 offset:1024
  ds_read_b128 v[52:55], v6 offset:2560
  ds_read_b128 v[120:123], v7 offset:512
  ds_read_b128 v[56:59], v6 offset:3072
  ds_read_b128 v[124:127], v7 offset:0
  ds_read_b128 v[60:63], v6 offset:3584
  s_waitcnt lgkmcnt(0)
  v_mfma_f32_16x16x32_bf16 v[128:131], v[32:35], v[96:99], 0
  ds_read_b128 v[160:163], v7 offset:3648
  v_mfma_f32_16x16x32_bf16 v[132:135], v[32:35], v[100:103], 0
  buffer_load_dword v210, v209, s[4:7], 0 offen offset:0
  v_mfma_f32_16x16x32_bf16 v[136:139], v[32:35], v[104:107], 0
  ds_read_b128 v[64:67], v6 offset:64
  v_mfma_f32_16x16x32_bf16 v[140:143], v[32:35], v[108:111], 0
  v_mfma_f32_16x16x32_bf16 v[144:147], v[32:35], v[112:115], 0
  ds_read_b128 v[164:167], v7 offset:3136
  v_mfma_f32_16x16x32_bf16 v[148:151], v[32:35], v[116:119], 0
  v_mfma_f32_16x16x32_bf16 v[152:155], v[32:35], v[120:123], 0
  ds_read_b128 v[68:71], v6 offset:576
  v_mfma_f32_16x16x32_bf16 v[156:159], v[32:35], v[124:127], 0
  buffer_load_dword v211, v209, s[4:7], 0 offen offset:1024
  v_mfma_f32_16x16x32_bf16 v[132:135], v[36:39], v[96:99], v[132:135]
  ds_read_b128 v[168:171], v7 offset:2624
  v_mfma_f32_16x16x32_bf16 v[136:139], v[36:39], v[100:103], v[136:139]
  v_mfma_f32_16x16x32_bf16 v[140:143], v[36:39], v[104:107], v[140:143]
  ds_read_b128 v[72:75], v6 offset:1088
  v_mfma_f32_16x16x32_bf16 v[144:147], v[36:39], v[108:111], v[144:147]
  v_mfma_f32_16x16x32_bf16 v[148:151], v[36:39], v[112:115], v[148:151]
  ds_read_b128 v[172:175], v7 offset:2112
  v_mfma_f32_16x16x32_bf16 v[152:155], v[36:39], v[116:119], v[152:155]
  buffer_load_dword v212, v209, s[4:7], 0 offen offset:2048
  v_mfma_f32_16x16x32_bf16 v[156:159], v[36:39], v[120:123], v[156:159]
  ds_read_b128 v[76:79], v6 offset:1600
  v_mfma_f32_16x16x32_bf16 v[136:139], v[40:43], v[96:99], v[136:139]
  v_mfma_f32_16x16x32_bf16 v[140:143], v[40:43], v[100:103], v[140:143]
  ds_read_b128 v[176:179], v7 offset:1600
  v_mfma_f32_16x16x32_bf16 v[144:147], v[40:43], v[104:107], v[144:147]
  v_mfma_f32_16x16x32_bf16 v[148:151], v[40:43], v[108:111], v[148:151]
  ds_read_b128 v[80:83], v6 offset:2112
  v_mfma_f32_16x16x32_bf16 v[152:155], v[40:43], v[112:115], v[152:155]
  buffer_load_dword v213, v209, s[4:7], 0 offen offset:3072
  v_mfma_f32_16x16x32_bf16 v[156:159], v[40:43], v[116:119], v[156:159]
  ds_read_b128 v[180:183], v7 offset:1088
  v_mfma_f32_16x16x32_bf16 v[140:143], v[44:47], v[96:99], v[140:143]
  v_mfma_f32_16x16x32_bf16 v[144:147], v[44:47], v[100:103], v[144:147]
  ds_read_b128 v[84:87], v6 offset:2624
  v_mfma_f32_16x16x32_bf16 v[148:151], v[44:47], v[104:107], v[148:151]
  v_mfma_f32_16x16x32_bf16 v[152:155], v[44:47], v[108:111], v[152:155]
  ds_read_b128 v[184:187], v7 offset:576
  v_mfma_f32_16x16x32_bf16 v[156:159], v[44:47], v[112:115], v[156:159]
  buffer_load_dword v214, v209, s[4:7], s62 offen offset:0
  v_mfma_f32_16x16x32_bf16 v[144:147], v[48:51], v[96:99], v[144:147]
  ds_read_b128 v[88:91], v6 offset:3136
  v_mfma_f32_16x16x32_bf16 v[148:151], v[48:51], v[100:103], v[148:151]
  v_mfma_f32_16x16x32_bf16 v[152:155], v[48:51], v[104:107], v[152:155]
  ds_read_b128 v[188:191], v7 offset:64
  v_mfma_f32_16x16x32_bf16 v[156:159], v[48:51], v[108:111], v[156:159]
  v_mfma_f32_16x16x32_bf16 v[148:151], v[52:55], v[96:99], v[148:151]
  ds_read_b128 v[92:95], v6 offset:3648
  v_mfma_f32_16x16x32_bf16 v[152:155], v[52:55], v[100:103], v[152:155]
  buffer_load_dword v215, v209, s[4:7], s62 offen offset:1024
  v_mfma_f32_16x16x32_bf16 v[156:159], v[52:55], v[104:107], v[156:159]
  v_mfma_f32_16x16x32_bf16 v[152:155], v[56:59], v[96:99], v[152:155]
  v_mfma_f32_16x16x32_bf16 v[156:159], v[56:59], v[100:103], v[156:159]
  v_mfma_f32_16x16x32_bf16 v[156:159], v[60:63], v[96:99], v[156:159]
  s_waitcnt lgkmcnt(0)
  v_mfma_f32_16x16x32_bf16 v[128:131], v[64:67], v[160:163], v[128:131]
  ds_read_b128 v[96:99], v7 offset:3712
  v_mfma_f32_16x16x32_bf16 v[132:135], v[64:67], v[164:167], v[132:135]
  buffer_load_dword v216, v209, s[4:7], s62 offen offset:2048
  v_mfma_f32_16x16x32_bf16 v[136:139], v[64:67], v[168:171], v[136:139]
  ds_read_b128 v[32:35], v6 offset:128
  v_mfma_f32_16x16x32_bf16 v[140:143], v[64:67], v[172:175], v[140:143]
  v_mfma_f32_16x16x32_bf16 v[144:147], v[64:67], v[176:179], v[144:147]
  ds_read_b128 v[100:103], v7 offset:3200
  v_mfma_f32_16x16x32_bf16 v[148:151], v[64:67], v[180:183], v[148:151]
  v_mfma_f32_16x16x32_bf16 v[152:155], v[64:67], v[184:187], v[152:155]
  ds_read_b128 v[36:39], v6 offset:640
  v_mfma_f32_16x16x32_bf16 v[156:159], v[64:67], v[188:191], v[156:159]
  buffer_load_dword v217, v209, s[4:7], s62 offen offset:3072
  v_mfma_f32_16x16x32_bf16 v[132:135], v[68:71], v[160:163], v[132:135]
  ds_read_b128 v[104:107], v7 offset:2688
  v_mfma_f32_16x16x32_bf16 v[136:139], v[68:71], v[164:167], v[136:139]
  v_mfma_f32_16x16x32_bf16 v[140:143], v[68:71], v[168:171], v[140:143]
  ds_read_b128 v[40:43], v6 offset:1152
  v_mfma_f32_16x16x32_bf16 v[144:147], v[68:71], v[172:175], v[144:147]
  v_mfma_f32_16x16x32_bf16 v[148:151], v[68:71], v[176:179], v[148:151]
  ds_read_b128 v[108:111], v7 offset:2176
  v_mfma_f32_16x16x32_bf16 v[152:155], v[68:71], v[180:183], v[152:155]
  buffer_load_dword v228, v226, s[76:79], 0 offen
  v_mfma_f32_16x16x32_bf16 v[156:159], v[68:71], v[184:187], v[156:159]
  ds_read_b128 v[44:47], v6 offset:1664
  v_mfma_f32_16x16x32_bf16 v[136:139], v[72:75], v[160:163], v[136:139]
  v_mfma_f32_16x16x32_bf16 v[140:143], v[72:75], v[164:167], v[140:143]
  ds_read_b128 v[112:115], v7 offset:1664
  v_mfma_f32_16x16x32_bf16 v[144:147], v[72:75], v[168:171], v[144:147]
  v_mfma_f32_16x16x32_bf16 v[148:151], v[72:75], v[172:175], v[148:151]
  ds_read_b128 v[48:51], v6 offset:2176
  v_mfma_f32_16x16x32_bf16 v[152:155], v[72:75], v[176:179], v[152:155]
  v_mfma_f32_16x16x32_bf16 v[156:159], v[72:75], v[180:183], v[156:159]
  ds_read_b128 v[116:119], v7 offset:1152
  v_mfma_f32_16x16x32_bf16 v[140:143], v[76:79], v[160:163], v[140:143]
  v_mfma_f32_16x16x32_bf16 v[144:147], v[76:79], v[164:167], v[144:147]
  ds_read_b128 v[52:55], v6 offset:2688
  v_mfma_f32_16x16x32_bf16 v[148:151], v[76:79], v[168:171], v[148:151]
  v_mfma_f32_16x16x32_bf16 v[152:155], v[76:79], v[172:175], v[152:155]
  ds_read_b128 v[120:123], v7 offset:640
  v_mfma_f32_16x16x32_bf16 v[156:159], v[76:79], v[176:179], v[156:159]
  v_mfma_f32_16x16x32_bf16 v[144:147], v[80:83], v[160:163], v[144:147]
  ds_read_b128 v[56:59], v6 offset:3200
  v_mfma_f32_16x16x32_bf16 v[148:151], v[80:83], v[164:167], v[148:151]
  v_mfma_f32_16x16x32_bf16 v[152:155], v[80:83], v[168:171], v[152:155]
  ds_read_b128 v[124:127], v7 offset:128
  v_mfma_f32_16x16x32_bf16 v[156:159], v[80:83], v[172:175], v[156:159]
  v_mfma_f32_16x16x32_bf16 v[148:151], v[84:87], v[160:163], v[148:151]
  ds_read_b128 v[60:63], v6 offset:3712
  v_mfma_f32_16x16x32_bf16 v[152:155], v[84:87], v[164:167], v[152:155]
  v_mfma_f32_16x16x32_bf16 v[156:159], v[84:87], v[168:171], v[156:159]
  v_mfma_f32_16x16x32_bf16 v[152:155], v[88:91], v[160:163], v[152:155]
  v_mfma_f32_16x16x32_bf16 v[156:159], v[88:91], v[164:167], v[156:159]
  v_mfma_f32_16x16x32_bf16 v[156:159], v[92:95], v[160:163], v[156:159]
  s_waitcnt vmcnt(10)
  s_waitcnt lgkmcnt(0)
  v_mfma_f32_16x16x32_bf16 v[128:131], v[32:35], v[96:99], v[128:131]
  ds_read_b128 v[160:163], v7 offset:3776
  v_lshlrev_b32 v220, 16, v220
  v_mfma_f32_16x16x32_bf16 v[132:135], v[32:35], v[100:103], v[132:135]
  v_lshlrev_b32 v221, 16, v221
  v_lshlrev_b32 v222, 16, v222
  v_mfma_f32_16x16x32_bf16 v[136:139], v[32:35], v[104:107], v[136:139]
  ds_read_b128 v[64:67], v6 offset:192
  v_lshlrev_b32 v223, 16, v223
  v_mfma_f32_16x16x32_bf16 v[140:143], v[32:35], v[108:111], v[140:143]
  v_mul_f32 v248, 0xbfb8aa3b, v220
  v_mul_f32 v249, 0xbfb8aa3b, v221
  v_mfma_f32_16x16x32_bf16 v[144:147], v[32:35], v[112:115], v[144:147]
  ds_read_b128 v[164:167], v7 offset:3264
  v_mul_f32 v250, 0xbfb8aa3b, v222
  v_mfma_f32_16x16x32_bf16 v[148:151], v[32:35], v[116:119], v[148:151]
  v_mul_f32 v251, 0xbfb8aa3b, v223
  v_exp_f32 v248, v248
  v_mfma_f32_16x16x32_bf16 v[152:155], v[32:35], v[120:123], v[152:155]
  ds_read_b128 v[68:71], v6 offset:704
  v_exp_f32 v249, v249
  v_mfma_f32_16x16x32_bf16 v[156:159], v[32:35], v[124:127], v[156:159]
  v_exp_f32 v250, v250
  v_exp_f32 v251, v251
  v_mfma_f32_16x16x32_bf16 v[132:135], v[36:39], v[96:99], v[132:135]
  ds_read_b128 v[168:171], v7 offset:2752
  v_add_f32 v248, 1.0, v248
  v_mfma_f32_16x16x32_bf16 v[136:139], v[36:39], v[100:103], v[136:139]
  v_add_f32 v249, 1.0, v249
  v_add_f32 v250, 1.0, v250
  v_mfma_f32_16x16x32_bf16 v[140:143], v[36:39], v[104:107], v[140:143]
  ds_read_b128 v[72:75], v6 offset:1216
  v_add_f32 v251, 1.0, v251
  v_mfma_f32_16x16x32_bf16 v[144:147], v[36:39], v[108:111], v[144:147]
  v_rcp_f32 v248, v248
  v_rcp_f32 v249, v249
  v_mfma_f32_16x16x32_bf16 v[148:151], v[36:39], v[112:115], v[148:151]
  ds_read_b128 v[172:175], v7 offset:2240
  v_rcp_f32 v250, v250
  v_mfma_f32_16x16x32_bf16 v[152:155], v[36:39], v[116:119], v[152:155]
  v_rcp_f32 v251, v251
  v_mul_f32 v220, v220, v248
  v_mfma_f32_16x16x32_bf16 v[156:159], v[36:39], v[120:123], v[156:159]
  ds_read_b128 v[76:79], v6 offset:1728
  v_mul_f32 v221, v221, v249
  v_mfma_f32_16x16x32_bf16 v[136:139], v[40:43], v[96:99], v[136:139]
  v_mul_f32 v222, v222, v250
  v_mul_f32 v223, v223, v251
  v_mfma_f32_16x16x32_bf16 v[140:143], v[40:43], v[100:103], v[140:143]
  ds_read_b128 v[176:179], v7 offset:1728
  v_cvt_pk_bf16_f32 v220, 0, v220
  v_mfma_f32_16x16x32_bf16 v[144:147], v[40:43], v[104:107], v[144:147]
  v_cvt_pk_bf16_f32 v221, 0, v221
  v_cvt_pk_bf16_f32 v222, 0, v222
  v_mfma_f32_16x16x32_bf16 v[148:151], v[40:43], v[108:111], v[148:151]
  ds_read_b128 v[80:83], v6 offset:2240
  v_cvt_pk_bf16_f32 v223, 0, v223
  v_mfma_f32_16x16x32_bf16 v[152:155], v[40:43], v[112:115], v[152:155]
  v_lshlrev_b32 v232, 16, v192
  v_and_b32 v233, 0xffff0000, v192
  v_mfma_f32_16x16x32_bf16 v[156:159], v[40:43], v[116:119], v[156:159]
  ds_read_b128 v[180:183], v7 offset:1216
  v_lshlrev_b32 v234, 16, v193
  v_mfma_f32_16x16x32_bf16 v[140:143], v[44:47], v[96:99], v[140:143]
  v_and_b32 v235, 0xffff0000, v193
  v_lshlrev_b32 v236, 16, v194
  v_mfma_f32_16x16x32_bf16 v[144:147], v[44:47], v[100:103], v[144:147]
  ds_read_b128 v[84:87], v6 offset:2752
  v_and_b32 v237, 0xffff0000, v194
  v_mfma_f32_16x16x32_bf16 v[148:151], v[44:47], v[104:107], v[148:151]
  v_lshlrev_b32 v238, 16, v195
  v_and_b32 v239, 0xffff0000, v195
  v_mfma_f32_16x16x32_bf16 v[152:155], v[44:47], v[108:111], v[152:155]
  ds_read_b128 v[184:187], v7 offset:704
  v_mul_f32 v240, v232, v220
  v_mfma_f32_16x16x32_bf16 v[156:159], v[44:47], v[112:115], v[156:159]
  v_mul_f32 v241, v233, v220
  v_mul_f32 v242, v234, v220
  v_mfma_f32_16x16x32_bf16 v[144:147], v[48:51], v[96:99], v[144:147]
  ds_read_b128 v[88:91], v6 offset:3264
  v_mul_f32 v243, v235, v220
  v_mfma_f32_16x16x32_bf16 v[148:151], v[48:51], v[100:103], v[148:151]
  v_mul_f32 v244, v236, v220
  v_mul_f32 v245, v237, v220
  v_mfma_f32_16x16x32_bf16 v[152:155], v[48:51], v[104:107], v[152:155]
  ds_read_b128 v[188:191], v7 offset:192
  v_mul_f32 v246, v238, v220
  v_mfma_f32_16x16x32_bf16 v[156:159], v[48:51], v[108:111], v[156:159]
  v_mul_f32 v247, v239, v220
  v_lshlrev_b32 v232, 16, v196
  v_mfma_f32_16x16x32_bf16 v[148:151], v[52:55], v[96:99], v[148:151]
  ds_read_b128 v[92:95], v6 offset:3776
  v_and_b32 v233, 0xffff0000, v196
  v_mfma_f32_16x16x32_bf16 v[152:155], v[52:55], v[100:103], v[152:155]
  v_lshlrev_b32 v234, 16, v197
  v_and_b32 v235, 0xffff0000, v197
  v_mfma_f32_16x16x32_bf16 v[156:159], v[52:55], v[104:107], v[156:159]
  v_lshlrev_b32 v236, 16, v198
  v_and_b32 v237, 0xffff0000, v198
  v_mfma_f32_16x16x32_bf16 v[152:155], v[56:59], v[96:99], v[152:155]
  v_lshlrev_b32 v238, 16, v199
  v_and_b32 v239, 0xffff0000, v199
  v_mfma_f32_16x16x32_bf16 v[156:159], v[56:59], v[100:103], v[156:159]
  v_fmac_f32 v240, v232, v221
  v_fmac_f32 v241, v233, v221
  v_mfma_f32_16x16x32_bf16 v[156:159], v[60:63], v[96:99], v[156:159]
  v_fmac_f32 v242, v234, v221
  v_fmac_f32 v243, v235, v221
  s_waitcnt lgkmcnt(0)
  v_mfma_f32_16x16x32_bf16 v[128:131], v[64:67], v[160:163], v[128:131]
  v_fmac_f32 v244, v236, v221
  v_fmac_f32 v245, v237, v221
  v_mfma_f32_16x16x32_bf16 v[132:135], v[64:67], v[164:167], v[132:135]
  v_fmac_f32 v246, v238, v221
  v_fmac_f32 v247, v239, v221
  v_mfma_f32_16x16x32_bf16 v[136:139], v[64:67], v[168:171], v[136:139]
  v_lshlrev_b32 v232, 16, v200
  v_and_b32 v233, 0xffff0000, v200
  v_mfma_f32_16x16x32_bf16 v[140:143], v[64:67], v[172:175], v[140:143]
  v_lshlrev_b32 v234, 16, v201
  v_and_b32 v235, 0xffff0000, v201
  v_mfma_f32_16x16x32_bf16 v[144:147], v[64:67], v[176:179], v[144:147]
  v_lshlrev_b32 v236, 16, v202
  v_and_b32 v237, 0xffff0000, v202
  v_mfma_f32_16x16x32_bf16 v[148:151], v[64:67], v[180:183], v[148:151]
  v_lshlrev_b32 v238, 16, v203
  v_and_b32 v239, 0xffff0000, v203
  v_mfma_f32_16x16x32_bf16 v[152:155], v[64:67], v[184:187], v[152:155]
  v_fmac_f32 v240, v232, v222
  v_fmac_f32 v241, v233, v222
  v_mfma_f32_16x16x32_bf16 v[156:159], v[64:67], v[188:191], v[156:159]
  v_fmac_f32 v242, v234, v222
  v_fmac_f32 v243, v235, v222
  v_mfma_f32_16x16x32_bf16 v[132:135], v[68:71], v[160:163], v[132:135]
  v_fmac_f32 v244, v236, v222
  v_fmac_f32 v245, v237, v222
  v_mfma_f32_16x16x32_bf16 v[136:139], v[68:71], v[164:167], v[136:139]
  v_fmac_f32 v246, v238, v222
  v_fmac_f32 v247, v239, v222
  v_mfma_f32_16x16x32_bf16 v[140:143], v[68:71], v[168:171], v[140:143]
  v_lshlrev_b32 v232, 16, v204
  v_and_b32 v233, 0xffff0000, v204
  v_mfma_f32_16x16x32_bf16 v[144:147], v[68:71], v[172:175], v[144:147]
  v_lshlrev_b32 v234, 16, v205
  v_and_b32 v235, 0xffff0000, v205
  v_mfma_f32_16x16x32_bf16 v[148:151], v[68:71], v[176:179], v[148:151]
  v_lshlrev_b32 v236, 16, v206
  v_and_b32 v237, 0xffff0000, v206
  v_mfma_f32_16x16x32_bf16 v[152:155], v[68:71], v[180:183], v[152:155]
  v_lshlrev_b32 v238, 16, v207
  v_and_b32 v239, 0xffff0000, v207
  v_mfma_f32_16x16x32_bf16 v[156:159], v[68:71], v[184:187], v[156:159]
  v_fmac_f32 v240, v232, v223
  v_fmac_f32 v241, v233, v223
  v_mfma_f32_16x16x32_bf16 v[136:139], v[72:75], v[160:163], v[136:139]
  v_fmac_f32 v242, v234, v223
  v_fmac_f32 v243, v235, v223
  v_mfma_f32_16x16x32_bf16 v[140:143], v[72:75], v[164:167], v[140:143]
  v_fmac_f32 v244, v236, v223
  v_fmac_f32 v245, v237, v223
  v_mfma_f32_16x16x32_bf16 v[144:147], v[72:75], v[168:171], v[144:147]
  v_fmac_f32 v246, v238, v223
  v_fmac_f32 v247, v239, v223
  v_mfma_f32_16x16x32_bf16 v[148:151], v[72:75], v[172:175], v[148:151]
  v_permlane32_swap_b32 v240, v241
  v_permlane32_swap_b32 v242, v243
  v_mfma_f32_16x16x32_bf16 v[152:155], v[72:75], v[176:179], v[152:155]
  v_permlane32_swap_b32 v244, v245
  v_permlane32_swap_b32 v246, v247
  v_mfma_f32_16x16x32_bf16 v[156:159], v[72:75], v[180:183], v[156:159]
  v_add_f32 v240, v240, v241
  v_add_f32 v242, v242, v243
  v_mfma_f32_16x16x32_bf16 v[140:143], v[76:79], v[160:163], v[140:143]
  v_add_f32 v244, v244, v245
  v_add_f32 v246, v246, v247
  v_mfma_f32_16x16x32_bf16 v[144:147], v[76:79], v[164:167], v[144:147]
  v_permlane16_swap_b32 v240, v242
  v_permlane16_swap_b32 v244, v246
  v_mfma_f32_16x16x32_bf16 v[148:151], v[76:79], v[168:171], v[148:151]
  v_add_f32 v240, v240, v242
  v_add_f32 v244, v244, v246
  v_mfma_f32_16x16x32_bf16 v[152:155], v[76:79], v[172:175], v[152:155]
  v_and_b32 v232, 8, v1
  v_cmp_eq_u32 vcc, 8, v232
  v_mfma_f32_16x16x32_bf16 v[156:159], v[76:79], v[176:179], v[156:159]
  s_nop 0
  v_cndmask_b32 v233, v244, v240, vcc
  v_cndmask_b32 v240, v240, v244, vcc
  v_mfma_f32_16x16x32_bf16 v[144:147], v[80:83], v[160:163], v[144:147]
  s_nop 0
  v_add_f32_dpp v240, v233, v240 row_ror:8 row_mask:0xf bank_mask:0xf
  v_lshrrev_b32 v232, 5, v1
  v_mfma_f32_16x16x32_bf16 v[148:151], v[80:83], v[164:167], v[148:151]
  v_bfe_u32 v233, v1, 4, 1
  v_lshl_add_u32 v232, v233, 1, v232
  v_mfma_f32_16x16x32_bf16 v[152:155], v[80:83], v[168:171], v[152:155]
  v_bfe_u32 v233, v1, 3, 1
  v_lshl_add_u32 v232, v233, 2, v232
  v_mfma_f32_16x16x32_bf16 v[156:159], v[80:83], v[172:175], v[156:159]
  v_and_b32 v233, 7, v1
  v_lshl_add_u32 v232, v233, 3, v232
  v_mfma_f32_16x16x32_bf16 v[148:151], v[84:87], v[160:163], v[148:151]
  v_lshlrev_b32 v232, 2, v232
  v_add_u32 v232, s75, v232
  v_mfma_f32_16x16x32_bf16 v[152:155], v[84:87], v[164:167], v[152:155]
  v_mfma_f32_16x16x32_bf16 v[156:159], v[84:87], v[168:171], v[156:159]
  v_mfma_f32_16x16x32_bf16 v[152:155], v[88:91], v[160:163], v[152:155]
  v_mfma_f32_16x16x32_bf16 v[156:159], v[88:91], v[164:167], v[156:159]
  v_mfma_f32_16x16x32_bf16 v[156:159], v[92:95], v[160:163], v[156:159]
  s_lshl_b32 s57, s3, 13
  s_add_u32 s57, s57, 51840
  v_lshlrev_b32 v8, 4, v1
  v_add_u32 v9, s57, v8
  s_cmp_eq_u32 s64, 0
  s_cbranch_scc1 P1_W0
  ds_write_b128 v9, v[128:131] offset:0
  ds_write_b128 v9, v[132:135] offset:1024
  ds_write_b128 v9, v[136:139] offset:2048
  ds_write_b128 v9, v[140:143] offset:3072
  v_mov_b32 v32, v144
  v_mov_b32 v33, v145
  v_mov_b32 v34, v146
  v_mov_b32 v35, v147
  v_mov_b32 v36, v148
  v_mov_b32 v37, v149
  v_mov_b32 v38, v150
  v_mov_b32 v39, v151
  v_mov_b32 v40, v152
  v_mov_b32 v41, v153
  v_mov_b32 v42, v154
  v_mov_b32 v43, v155
  v_mov_b32 v44, v156
  v_mov_b32 v45, v157
  v_mov_b32 v46, v158
  v_mov_b32 v47, v159
  s_branch P1_W1
P1_W0:
  ds_write_b128 v9, v[144:147] offset:0
  ds_write_b128 v9, v[148:151] offset:1024
  ds_write_b128 v9, v[152:155] offset:2048
  ds_write_b128 v9, v[156:159] offset:3072
  v_mov_b32 v32, v128
  v_mov_b32 v33, v129
  v_mov_b32 v34, v130
  v_mov_b32 v35, v131
  v_mov_b32 v36, v132
  v_mov_b32 v37, v133
  v_mov_b32 v38, v134
  v_mov_b32 v39, v135
  v_mov_b32 v40, v136
  v_mov_b32 v41, v137
  v_mov_b32 v42, v138
  v_mov_b32 v43, v139
  v_mov_b32 v44, v140
  v_mov_b32 v45, v141
  v_mov_b32 v46, v142
  v_mov_b32 v47, v143
P1_W1:
  s_xor_b32 s57, s3, 1
  s_lshl_b32 s57, s57, 13
  s_add_u32 s57, s57, 51840
  v_add_u32 v9, s57, v8
  s_waitcnt vmcnt(9)
  s_cmp_lg_u32 s3, 0
  s_cbranch_scc1 P1_ROOT_OK
  v_cmp_gt_u32 vcc, 8, v225
  s_nop 3
  s_cbranch_vccz P1_ROOT_OK
  s_mov_b32 s12, s40
  s_mov_b32 s13, s41
  s_mov_b32 s14, 0x100
  s_mov_b32 s15, 0x20000
  s_mov_b32 s56, 0
  buffer_load_dword v226, v224, s[12:15], 0 offen sc1
POLL3:
  buffer_load_dword v227, v224, s[12:15], 0 offen sc1
  s_waitcnt vmcnt(1)
  v_cmp_gt_u32 vcc, 8, v226
  s_nop 3
  s_cbranch_vccz POLLD4
  buffer_load_dword v226, v224, s[12:15], 0 offen sc1
  s_waitcnt vmcnt(1)
  v_cmp_gt_u32 vcc, 8, v227
  s_nop 3
  s_cbranch_vccz POLLD4
  s_add_u32 s56, s56, 1
  s_cmp_lt_u32 s56, 400000
  s_cbranch_scc1 POLL3
POLLD4:
  s_waitcnt vmcnt(0)
P1_ROOT_OK:
  s_waitcnt lgkmcnt(0)
  s_barrier
  ds_read_b128 v[48:51], v9 offset:0
  ds_read_b128 v[52:55], v9 offset:1024
  ds_read_b128 v[56:59], v9 offset:2048
  ds_read_b128 v[60:63], v9 offset:3072
  v_and_b32 v10, 1, v4
  v_mul_u32_u24 v10, 4640, v10
  v_lshrrev_b32 v11, 1, v4
  v_lshlrev_b32 v11, 6, v11
  v_sub_u32 v10, v10, v11
  v_lshlrev_b32 v11, 4, v5
  v_sub_u32 v10, v10, v11
  s_mul_i32 s57, s63, 9280
  s_add_u32 s57, s57, 35824
  s_lshl_b32 s58, s64, 11
  s_sub_u32 s57, s57, s58
  v_add_u32 v10, s57, v10
  ds_read_b128 v[64:67], v10 offset:1536
  ds_read_b128 v[68:71], v10 offset:1024
  ds_read_b128 v[72:75], v10 offset:512
  ds_read_b128 v[76:79], v10 offset:0
  s_add_u32 s48, s42, 0xf80000
  s_addc_u32 s49, s43, 0
  s_mov_b32 s50, 0x3000
  s_mov_b32 s51, 0x20000
  buffer_atomic_add_f32 v240, v232, s[48:51], 0 offen sc1
  s_add_u32 s8, s42, 0x240000
  s_addc_u32 s9, s43, 0
  s_mov_b32 s10, 0x210000
  s_mov_b32 s11, 0x20000
  v_and_b32 v12, 1, v4
  v_lshlrev_b32 v12, 3, v12
  v_lshl_add_u32 v12, v5, 4, v12
  v_lshrrev_b32 v13, 1, v4
  v_lshl_add_u32 v12, v13, 6, v12
  s_mul_i32 s57, s66, 4224
  s_lshl_b32 s58, s64, 11
  s_add_u32 s57, s57, s58
  v_add_u32 v12, s57, v12
  v_and_b32 v13, 1, v4
  v_cmp_eq_u32 vcc, 1, v13
  v_mov_b32 v14, 0x05040100
  v_mov_b32 v15, 0x01000504
  v_cndmask_b32 v14, v14, v15, vcc
  v_mov_b32 v15, 0x07060302
  v_mov_b32 v16, 0x03020706
  v_cndmask_b32 v15, v15, v16, vcc
  s_waitcnt lgkmcnt(0)
  v_pk_add_f32 v[32:33], v[32:33], v[48:49]
  v_pk_add_f32 v[34:35], v[34:35], v[50:51]
  v_lshlrev_b32 v48, 16, v67
  v_lshlrev_b32 v49, 16, v66
  v_lshlrev_b32 v50, 16, v65
  v_lshlrev_b32 v51, 16, v64
  v_cvt_pk_bf16_f32 v32, 0, v32
  v_cvt_pk_bf16_f32 v33, 0, v33
  v_cvt_pk_bf16_f32 v34, 0, v34
  v_cvt_pk_bf16_f32 v35, 0, v35
  v_pk_mul_f32 v[48:49], v[48:49], v[24:25] op_sel:[0,1]
  v_pk_mul_f32 v[50:51], v[50:51], v[24:25] op_sel:[0,1]
  v_cvt_pk_bf16_f32 v48, 0, v48
  v_cvt_pk_bf16_f32 v49, 0, v49
  v_cvt_pk_bf16_f32 v50, 0, v50
  v_cvt_pk_bf16_f32 v51, 0, v51
  v_pk_add_f32 v[32:33], v[32:33], v[48:49]
  v_pk_add_f32 v[34:35], v[34:35], v[50:51]
  v_cvt_pk_bf16_f32 v82, v32, v33
  v_cvt_pk_bf16_f32 v83, v34, v35
  v_cndmask_b32 v84, v83, v82, vcc
  v_cndmask_b32 v85, v82, v83, vcc
  s_nop 0
  v_mov_b32_dpp v86, v84 quad_perm:[1,0,3,2] row_mask:0xf bank_mask:0xf
  v_perm_b32 v88, v86, v85, v14
  v_perm_b32 v89, v86, v85, v15
  buffer_store_dwordx2 v[88:89], v12, s[8:11], 0 offen offset:0 sc1
  v_pk_add_f32 v[36:37], v[36:37], v[52:53]
  v_pk_add_f32 v[38:39], v[38:39], v[54:55]
  v_lshlrev_b32 v52, 16, v71
  v_lshlrev_b32 v53, 16, v70
  v_lshlrev_b32 v54, 16, v69
  v_lshlrev_b32 v55, 16, v68
  v_cvt_pk_bf16_f32 v36, 0, v36
  v_cvt_pk_bf16_f32 v37, 0, v37
  v_cvt_pk_bf16_f32 v38, 0, v38
  v_cvt_pk_bf16_f32 v39, 0, v39
  v_pk_mul_f32 v[52:53], v[52:53], v[24:25] op_sel:[0,1]
  v_pk_mul_f32 v[54:55], v[54:55], v[24:25] op_sel:[0,1]
  v_cvt_pk_bf16_f32 v52, 0, v52
  v_cvt_pk_bf16_f32 v53, 0, v53
  v_cvt_pk_bf16_f32 v54, 0, v54
  v_cvt_pk_bf16_f32 v55, 0, v55
  v_pk_add_f32 v[36:37], v[36:37], v[52:53]
  v_pk_add_f32 v[38:39], v[38:39], v[54:55]
  v_cvt_pk_bf16_f32 v82, v36, v37
  v_cvt_pk_bf16_f32 v83, v38, v39
  v_cndmask_b32 v84, v83, v82, vcc
  v_cndmask_b32 v85, v82, v83, vcc
  s_nop 0
  v_mov_b32_dpp v86, v84 quad_perm:[1,0,3,2] row_mask:0xf bank_mask:0xf
  v_perm_b32 v90, v86, v85, v14
  v_perm_b32 v91, v86, v85, v15
  buffer_store_dwordx2 v[90:91], v12, s[8:11], 0 offen offset:512 sc1
  v_pk_add_f32 v[40:41], v[40:41], v[56:57]
  v_pk_add_f32 v[42:43], v[42:43], v[58:59]
  v_lshlrev_b32 v56, 16, v75
  v_lshlrev_b32 v57, 16, v74
  v_lshlrev_b32 v58, 16, v73
  v_lshlrev_b32 v59, 16, v72
  v_cvt_pk_bf16_f32 v40, 0, v40
  v_cvt_pk_bf16_f32 v41, 0, v41
  v_cvt_pk_bf16_f32 v42, 0, v42
  v_cvt_pk_bf16_f32 v43, 0, v43
  v_pk_mul_f32 v[56:57], v[56:57], v[24:25] op_sel:[0,1]
  v_pk_mul_f32 v[58:59], v[58:59], v[24:25] op_sel:[0,1]
  v_cvt_pk_bf16_f32 v56, 0, v56
  v_cvt_pk_bf16_f32 v57, 0, v57
  v_cvt_pk_bf16_f32 v58, 0, v58
  v_cvt_pk_bf16_f32 v59, 0, v59
  v_pk_add_f32 v[40:41], v[40:41], v[56:57]
  v_pk_add_f32 v[42:43], v[42:43], v[58:59]
  v_cvt_pk_bf16_f32 v82, v40, v41
  v_cvt_pk_bf16_f32 v83, v42, v43
  v_cndmask_b32 v84, v83, v82, vcc
  v_cndmask_b32 v85, v82, v83, vcc
  s_nop 0
  v_mov_b32_dpp v86, v84 quad_perm:[1,0,3,2] row_mask:0xf bank_mask:0xf
  v_perm_b32 v88, v86, v85, v14
  v_perm_b32 v89, v86, v85, v15
  buffer_store_dwordx2 v[88:89], v12, s[8:11], 0 offen offset:1024 sc1
  v_pk_add_f32 v[44:45], v[44:45], v[60:61]
  v_pk_add_f32 v[46:47], v[46:47], v[62:63]
  v_lshlrev_b32 v60, 16, v79
  v_lshlrev_b32 v61, 16, v78
  v_lshlrev_b32 v62, 16, v77
  v_lshlrev_b32 v63, 16, v76
  v_cvt_pk_bf16_f32 v44, 0, v44
  v_cvt_pk_bf16_f32 v45, 0, v45
  v_cvt_pk_bf16_f32 v46, 0, v46
  v_cvt_pk_bf16_f32 v47, 0, v47
  v_pk_mul_f32 v[60:61], v[60:61], v[24:25] op_sel:[0,1]
  v_pk_mul_f32 v[62:63], v[62:63], v[24:25] op_sel:[0,1]
  v_cvt_pk_bf16_f32 v60, 0, v60
  v_cvt_pk_bf16_f32 v61, 0, v61
  v_cvt_pk_bf16_f32 v62, 0, v62
  v_cvt_pk_bf16_f32 v63, 0, v63
  v_pk_add_f32 v[44:45], v[44:45], v[60:61]
  v_pk_add_f32 v[46:47], v[46:47], v[62:63]
  v_cvt_pk_bf16_f32 v82, v44, v45
  v_cvt_pk_bf16_f32 v83, v46, v47
  v_cndmask_b32 v84, v83, v82, vcc
  v_cndmask_b32 v85, v82, v83, vcc
  s_nop 0
  v_mov_b32_dpp v86, v84 quad_perm:[1,0,3,2] row_mask:0xf bank_mask:0xf
  v_perm_b32 v90, v86, v85, v14
  v_perm_b32 v91, v86, v85, v15
  buffer_store_dwordx2 v[90:91], v12, s[8:11], 0 offen offset:1536 sc1
  s_waitcnt vmcnt(0)
  s_barrier
  s_cmp_lg_u32 s3, 0
  s_cbranch_scc1 X2S_SKIP
  v_lshlrev_b32 v4, 10, v1
  s_lshl_b32 s57, s44, 7
  s_add_u32 s57, s57, 8192
  v_add_u32 v4, s57, v4
  v_mov_b32 v6, 0x40000000
  v_cmp_gt_u32 vcc, 8, v1
  s_nop 1
  v_cndmask_b32 v4, v6, v4, vcc
  v_mov_b32 v5, 1
  buffer_atomic_add v5, v4, s[80:83], 0 offen sc1
X2S_SKIP:
  s_lshr_b32 s56, s44, 2
  s_lshl_b32 s56, s56, 3
  s_lshr_b32 s57, s45, 2
  s_add_u32 s47, s56, s57
  s_and_b32 s56, s44, 3
  s_lshl_b32 s56, s56, 2
  s_and_b32 s57, s45, 3
  s_add_u32 s63, s56, s57
  s_cmp_lt_u32 s3, 2
  s_cselect_b32 s88, s28, s30
  s_cselect_b32 s89, s29, s31
  s_mov_b32 s90, 1835008
  s_mov_b32 s91, 0x20000
  s_lshl_b32 s86, s3, 12
  s_mul_i32 s87, s3, 3072
  s_and_b32 s58, s3, 1
  s_mul_i32 s57, s58, 114688
  s_lshl_b32 s56, s63, 7
  s_add_u32 s57, s57, s56
  v_lshrrev_b32 v3, 3, v1
  v_mul_u32_u24 v3, 3584, v3
  v_lshrrev_b32 v4, 4, v1
  v_lshlrev_b32 v4, 1, v4
  v_and_b32 v5, 7, v1
  v_xor_b32 v4, v4, v5
  v_lshl_add_u32 v3, v4, 4, v3
  v_add_u32 v240, s57, v3
  v_add_u32 v241, 27648, v240
  v_add_u32 v242, 27648, v241
  v_add_u32 v243, 27648, v242
  s_mov_b32 s52, s32
  s_mov_b32 s53, s33
  s_mov_b32 s54, 0x1c0000
  s_mov_b32 s55, 0x20000
  v_lshrrev_b32 v3, 3, v1
  v_lshlrev_b32 v3, 10, v3
  v_bfe_u32 v4, v1, 4, 1
  v_lshlrev_b32 v4, 1, v4
  v_and_b32 v5, 7, v1
  v_xor_b32 v4, v4, v5
  v_lshl_add_u32 v6, v4, 4, v3
  v_xor_b32 v4, 4, v4
  v_lshl_add_u32 v7, v4, 4, v3
  s_and_b32 s56, s46, 7
  s_lshl_b32 s56, s56, 7
  s_lshl_b32 s96, s3, 18
  s_mul_i32 s98, s3, 196608
  s_add_u32 s98, s98, 1048576
  v_add_u32 v247, s56, v6
  v_add_u32 v248, s56, v7
  v_add_u32 v248, 7168, v248
  v_add_u32 v249, 14336, v247
  v_add_u32 v250, 14336, v248
  s_mul_i32 s61, s3, 28928
  s_lshl_b32 s60, s3, 13
  s_add_u32 s60, s60, 131072
  v_lshrrev_b32 v3, 4, v1
  v_bfe_u32 v5, v1, 2, 2
  v_lshl_add_u32 v6, v3, 3, v5
  v_lshlrev_b32 v6, 7, v6
  v_and_b32 v7, 3, v1
  v_lshl_add_u32 v6, v7, 3, v6
  v_lshrrev_b32 v5, 1, v5
  v_and_b32 v3, 1, v3
  v_lshl_add_u32 v5, v3, 1, v5
  v_lshlrev_b32 v5, 1, v5
  v_xor_b32 v7, 0, v5
  v_lshl_add_u32 v251, v7, 4, v6
  v_xor_b32 v7, 2, v5
  v_lshl_add_u32 v252, v7, 4, v6
  v_xor_b32 v7, 4, v5
  v_lshl_add_u32 v253, v7, 4, v6
  v_xor_b32 v7, 6, v5
  v_lshl_add_u32 v254, v7, 4, v6
  v_add_u32 v251, s61, v251
  v_add_u32 v252, s61, v252
  v_add_u32 v253, s61, v253
  v_add_u32 v254, s61, v254
  v_lshlrev_b32 v40, 16, v210
  v_and_b32 v41, 0xffff0000, v210
  v_lshlrev_b32 v42, 16, v211
  v_and_b32 v43, 0xffff0000, v211
  v_lshlrev_b32 v44, 16, v212
  v_and_b32 v45, 0xffff0000, v212
  s_add_u32 m0, s61, 0
  s_add_u32 s99, s96, 0
  buffer_load_dwordx4 v247, s[52:55], s99 offen offset:0 lds
  v_lshlrev_b32 v46, 16, v213
  v_and_b32 v47, 0xffff0000, v213
  v_lshlrev_b32 v48, 16, v214
  v_and_b32 v49, 0xffff0000, v214
  v_lshlrev_b32 v50, 16, v215
  v_and_b32 v51, 0xffff0000, v215
  buffer_load_dwordx4 v248, s[52:55], s99 offen offset:1024 lds
  v_lshlrev_b32 v52, 16, v216
  v_and_b32 v53, 0xffff0000, v216
  v_lshlrev_b32 v54, 16, v217
  v_and_b32 v55, 0xffff0000, v217
  v_add_f32 v56, v40, v41
  v_mul_f32 v64, v40, v40
  buffer_load_dwordx4 v249, s[52:55], s99 offen offset:2048 lds
  v_add_f32 v57, v42, v43
  v_mul_f32 v65, v42, v42
  v_add_f32 v58, v44, v45
  v_mul_f32 v66, v44, v44
  v_add_f32 v59, v46, v47
  v_mul_f32 v67, v46, v46
  buffer_load_dwordx4 v250, s[52:55], s99 offen offset:3072 lds
  v_add_f32 v60, v48, v49
  v_mul_f32 v68, v48, v48
  v_add_f32 v61, v50, v51
  v_mul_f32 v69, v50, v50
  v_add_f32 v62, v52, v53
  v_mul_f32 v70, v52, v52
  s_add_u32 m0, s61, 4096
  s_add_u32 s99, s96, 32768
  buffer_load_dwordx4 v247, s[52:55], s99 offen offset:0 lds
  v_add_f32 v63, v54, v55
  v_mul_f32 v71, v54, v54
  v_fmac_f32 v64, v41, v41
  v_fmac_f32 v65, v43, v43
  v_fmac_f32 v66, v45, v45
  v_fmac_f32 v67, v47, v47
  buffer_load_dwordx4 v248, s[52:55], s99 offen offset:1024 lds
  v_fmac_f32 v68, v49, v49
  v_fmac_f32 v69, v51, v51
  v_fmac_f32 v70, v53, v53
  v_fmac_f32 v71, v55, v55
  v_and_b32 v72, 1, v1
  v_cmp_eq_u32 vcc, 1, v72
  buffer_load_dwordx4 v249, s[52:55], s99 offen offset:2048 lds
  s_nop 0
  v_cndmask_b32 v73, v57, v56, vcc
  v_cndmask_b32 v74, v59, v58, vcc
  v_cndmask_b32 v75, v61, v60, vcc
  v_cndmask_b32 v76, v63, v62, vcc
  v_cndmask_b32 v56, v56, v57, vcc
  v_cndmask_b32 v58, v58, v59, vcc
  buffer_load_dwordx4 v250, s[52:55], s99 offen offset:3072 lds
  v_cndmask_b32 v60, v60, v61, vcc
  v_cndmask_b32 v62, v62, v63, vcc
  v_add_f32_dpp v56, v73, v56 quad_perm:[1,0,3,2] row_mask:0xf bank_mask:0xf
  v_add_f32_dpp v58, v74, v58 quad_perm:[1,0,3,2] row_mask:0xf bank_mask:0xf
  v_add_f32_dpp v60, v75, v60 quad_perm:[1,0,3,2] row_mask:0xf bank_mask:0xf
  v_add_f32_dpp v62, v76, v62 quad_perm:[1,0,3,2] row_mask:0xf bank_mask:0xf
  s_add_u32 m0, s61, 8192
  s_add_u32 s99, s96, 65536
  buffer_load_dwordx4 v247, s[52:55], s99 offen offset:0 lds
  v_and_b32 v72, 1, v1
  v_cmp_eq_u32 vcc, 1, v72
  s_nop 1
  v_cndmask_b32 v73, v65, v64, vcc
  v_cndmask_b32 v74, v67, v66, vcc
  v_cndmask_b32 v75, v69, v68, vcc
  v_cndmask_b32 v76, v71, v70, vcc
  buffer_load_dwordx4 v248, s[52:55], s99 offen offset:1024 lds
  v_cndmask_b32 v64, v64, v65, vcc
  v_cndmask_b32 v66, v66, v67, vcc
  v_cndmask_b32 v68, v68, v69, vcc
  v_cndmask_b32 v70, v70, v71, vcc
  v_add_f32_dpp v64, v73, v64 quad_perm:[1,0,3,2] row_mask:0xf bank_mask:0xf
  v_add_f32_dpp v66, v74, v66 quad_perm:[1,0,3,2] row_mask:0xf bank_mask:0xf
  buffer_load_dwordx4 v249, s[52:55], s99 offen offset:2048 lds
  v_add_f32_dpp v68, v75, v68 quad_perm:[1,0,3,2] row_mask:0xf bank_mask:0xf
  v_add_f32_dpp v70, v76, v70 quad_perm:[1,0,3,2] row_mask:0xf bank_mask:0xf
  v_and_b32 v72, 2, v1
  v_cmp_eq_u32 vcc, 2, v72
  s_nop 1
  v_cndmask_b32 v73, v58, v56, vcc
  v_cndmask_b32 v74, v62, v60, vcc
  buffer_load_dwordx4 v250, s[52:55], s99 offen offset:3072 lds
  v_cndmask_b32 v75, v66, v64, vcc
  v_cndmask_b32 v76, v70, v68, vcc
  v_cndmask_b32 v56, v56, v58, vcc
  v_cndmask_b32 v60, v60, v62, vcc
  v_cndmask_b32 v64, v64, v66, vcc
  v_cndmask_b32 v68, v68, v70, vcc
  s_add_u32 m0, s61, 12288
  s_add_u32 s99, s96, 98304
  buffer_load_dwordx4 v247, s[52:55], s99 offen offset:0 lds
  v_add_f32_dpp v56, v73, v56 quad_perm:[2,3,0,1] row_mask:0xf bank_mask:0xf
  v_add_f32_dpp v60, v74, v60 quad_perm:[2,3,0,1] row_mask:0xf bank_mask:0xf
  v_add_f32_dpp v64, v75, v64 quad_perm:[2,3,0,1] row_mask:0xf bank_mask:0xf
  v_add_f32_dpp v68, v76, v68 quad_perm:[2,3,0,1] row_mask:0xf bank_mask:0xf
  v_and_b32 v72, 4, v1
  v_cmp_eq_u32 vcc, 4, v72
  buffer_load_dwordx4 v248, s[52:55], s99 offen offset:1024 lds
  s_nop 0
  v_cndmask_b32 v73, v60, v56, vcc
  v_cndmask_b32 v74, v68, v64, vcc
  v_cndmask_b32 v56, v56, v60, vcc
  v_cndmask_b32 v64, v64, v68, vcc
  v_mov_b32_dpp v75, v73 row_half_mirror row_mask:0xf bank_mask:0xf
  v_mov_b32_dpp v76, v74 row_half_mirror row_mask:0xf bank_mask:0xf
  buffer_load_dwordx4 v249, s[52:55], s99 offen offset:2048 lds
  v_add_f32_dpp v56, v75, v56 quad_perm:[3,2,1,0] row_mask:0xf bank_mask:0xf
  v_add_f32_dpp v64, v76, v64 quad_perm:[3,2,1,0] row_mask:0xf bank_mask:0xf
  s_nop 0
  v_add_f32_dpp v56, v56, v56 row_ror:8 row_mask:0xf bank_mask:0xf
  v_add_f32_dpp v64, v64, v64 row_ror:8 row_mask:0xf bank_mask:0xf
  v_mov_b32 v72, v56
  v_mov_b32 v73, v64
  buffer_load_dwordx4 v250, s[52:55], s99 offen offset:3072 lds
  v_permlane16_swap_b32 v72, v56
  v_permlane16_swap_b32 v73, v64
  v_add_f32 v56, v56, v72
  v_add_f32 v64, v64, v73
  v_mov_b32 v72, v56
  v_mov_b32 v73, v64
  s_add_u32 m0, s61, 16384
  s_add_u32 s99, s96, 131072
  buffer_load_dwordx4 v247, s[52:55], s99 offen offset:0 lds
  v_permlane32_swap_b32 v72, v56
  v_permlane32_swap_b32 v73, v64
  v_add_f32 v56, v56, v72
  v_add_f32 v64, v64, v73
  v_and_b32 v72, 7, v1
  v_lshlrev_b32 v72, 3, v72
  buffer_load_dwordx4 v248, s[52:55], s99 offen offset:1024 lds
  s_lshl_b32 s56, s3, 6
  s_add_u32 s56, s56, 135168
  v_add_u32 v73, s56, v72
  v_mov_b32 v58, v56
  v_mov_b32 v59, v64
  ds_write_b64 v73, v[58:59]
  v_add_u32 v72, 135168, v72
  s_waitcnt lgkmcnt(0)
  s_barrier
  ds_read_b64 v[60:61], v72 offset:0
  ds_read_b64 v[62:63], v72 offset:64
  ds_read_b64 v[64:65], v72 offset:128
  ds_read_b64 v[66:67], v72 offset:192
  s_waitcnt lgkmcnt(0)
  v_add_f32 v60, v60, v62
  v_add_f32 v61, v61, v63
  buffer_load_dwordx4 v249, s[52:55], s99 offen offset:2048 lds
  v_add_f32 v64, v64, v66
  v_add_f32 v65, v65, v67
  v_add_f32 v60, v60, v64
  v_add_f32 v61, v61, v65
  v_mul_f32 v60, 0x3b000000, v60
  v_mul_f32 v61, 0x3b000000, v61
  buffer_load_dwordx4 v250, s[52:55], s99 offen offset:3072 lds
  v_fma_f32 v61, -v60, v60, v61
  v_max_f32 v61, 0, v61
  v_cvt_pk_bf16_f32 v60, 0, v60
  v_cvt_pk_bf16_f32 v61, 0, v61
  v_add_f32 v61, 0x3727c5ac, v61
  v_cvt_pk_bf16_f32 v61, 0, v61
  s_add_u32 m0, s61, 20480
  s_add_u32 s99, s96, 163840
  buffer_load_dwordx4 v247, s[52:55], s99 offen offset:0 lds
  v_sqrt_f32 v61, v61
  s_nop 0
  v_cvt_pk_bf16_f32 v61, 0, v61
  v_rcp_f32 v61, v61
  v_readlane_b32 s64, v60, 0
  v_readlane_b32 s65, v60, 1
  v_readlane_b32 s66, v60, 2
  buffer_load_dwordx4 v248, s[52:55], s99 offen offset:1024 lds
  v_readlane_b32 s67, v60, 3
  v_readlane_b32 s68, v60, 4
  v_readlane_b32 s69, v60, 5
  v_readlane_b32 s70, v60, 6
  v_readlane_b32 s71, v60, 7
  v_readlane_b32 s72, v61, 0
  buffer_load_dwordx4 v249, s[52:55], s99 offen offset:2048 lds
  v_readlane_b32 s73, v61, 1
  v_readlane_b32 s74, v61, 2
  v_readlane_b32 s75, v61, 3
  v_readlane_b32 s76, v61, 4
  v_readlane_b32 s77, v61, 5
  v_readlane_b32 s78, v61, 6
  buffer_load_dwordx4 v250, s[52:55], s99 offen offset:3072 lds
  v_readlane_b32 s79, v61, 7
  v_pk_add_f32 v[112:113], v[40:41], s[64:65] op_sel_hi:[1,0] neg_lo:[0,1] neg_hi:[0,1]
  v_pk_add_f32 v[114:115], v[42:43], s[64:65] op_sel:[0,1] neg_lo:[0,1] neg_hi:[0,1]
  v_pk_add_f32 v[116:117], v[44:45], s[66:67] op_sel_hi:[1,0] neg_lo:[0,1] neg_hi:[0,1]
  v_pk_add_f32 v[118:119], v[46:47], s[66:67] op_sel:[0,1] neg_lo:[0,1] neg_hi:[0,1]
  v_pk_add_f32 v[120:121], v[48:49], s[68:69] op_sel_hi:[1,0] neg_lo:[0,1] neg_hi:[0,1]
  s_add_u32 m0, s61, 24576
  s_add_u32 s99, s96, 196608
  buffer_load_dwordx4 v247, s[52:55], s99 offen offset:0 lds
  v_pk_add_f32 v[122:123], v[50:51], s[68:69] op_sel:[0,1] neg_lo:[0,1] neg_hi:[0,1]
  v_pk_add_f32 v[124:125], v[52:53], s[70:71] op_sel_hi:[1,0] neg_lo:[0,1] neg_hi:[0,1]
  v_pk_add_f32 v[126:127], v[54:55], s[70:71] op_sel:[0,1] neg_lo:[0,1] neg_hi:[0,1]
  v_cvt_pk_bf16_f32 v112, 0, v112
  v_cvt_pk_bf16_f32 v113, 0, v113
  v_cvt_pk_bf16_f32 v114, 0, v114
  buffer_load_dwordx4 v248, s[52:55], s99 offen offset:1024 lds
  v_cvt_pk_bf16_f32 v115, 0, v115
  v_cvt_pk_bf16_f32 v116, 0, v116
  v_cvt_pk_bf16_f32 v117, 0, v117
  v_cvt_pk_bf16_f32 v118, 0, v118
  v_cvt_pk_bf16_f32 v119, 0, v119
  v_cvt_pk_bf16_f32 v120, 0, v120
  buffer_load_dwordx4 v249, s[52:55], s99 offen offset:2048 lds
  v_cvt_pk_bf16_f32 v121, 0, v121
  v_cvt_pk_bf16_f32 v122, 0, v122
  v_cvt_pk_bf16_f32 v123, 0, v123
  v_cvt_pk_bf16_f32 v124, 0, v124
  v_cvt_pk_bf16_f32 v125, 0, v125
  v_cvt_pk_bf16_f32 v126, 0, v126
  buffer_load_dwordx4 v250, s[52:55], s99 offen offset:3072 lds
  v_cvt_pk_bf16_f32 v127, 0, v127
  v_pk_mul_f32 v[112:113], v[112:113], s[72:73] op_sel_hi:[1,0]
  v_pk_mul_f32 v[114:115], v[114:115], s[72:73] op_sel:[0,1]
  v_pk_mul_f32 v[116:117], v[116:117], s[74:75] op_sel_hi:[1,0]
  v_pk_mul_f32 v[118:119], v[118:119], s[74:75] op_sel:[0,1]
  v_pk_mul_f32 v[120:121], v[120:121], s[76:77] op_sel_hi:[1,0]
  v_pk_mul_f32 v[122:123], v[122:123], s[76:77] op_sel:[0,1]
  v_pk_mul_f32 v[124:125], v[124:125], s[78:79] op_sel_hi:[1,0]
  v_pk_mul_f32 v[126:127], v[126:127], s[78:79] op_sel:[0,1]
  v_cvt_pk_bf16_f32 v112, 0, v112
  v_cvt_pk_bf16_f32 v113, 0, v113
  v_cvt_pk_bf16_f32 v114, 0, v114
  v_cvt_pk_bf16_f32 v115, 0, v115
  v_cvt_pk_bf16_f32 v116, 0, v116
  v_cvt_pk_bf16_f32 v117, 0, v117
  v_cvt_pk_bf16_f32 v118, 0, v118
  v_cvt_pk_bf16_f32 v119, 0, v119
  v_cvt_pk_bf16_f32 v120, 0, v120
  v_cvt_pk_bf16_f32 v121, 0, v121
  v_cvt_pk_bf16_f32 v122, 0, v122
  v_cvt_pk_bf16_f32 v123, 0, v123
  v_cvt_pk_bf16_f32 v124, 0, v124
  v_cvt_pk_bf16_f32 v125, 0, v125
  v_cvt_pk_bf16_f32 v126, 0, v126
  v_cvt_pk_bf16_f32 v127, 0, v127
  s_cmp_lg_u32 s3, 0
  s_cbranch_scc1 X2W_SKIP
  v_and_b32 v6, 7, v1
  v_lshlrev_b32 v6, 7, v6
  s_lshl_b32 s57, s44, 10
  s_add_u32 s57, s57, 8192
  v_add_u32 v6, s57, v6
  s_mov_b32 s56, 0
  buffer_load_dword v128, v6, s[80:83], 0 offen sc1
POLL5:
  buffer_load_dword v129, v6, s[80:83], 0 offen sc1
  s_waitcnt vmcnt(1)
  v_cmp_gt_u32 vcc, 32, v128
  s_nop 3
  s_cbranch_vccz POLLD6
  buffer_load_dword v128, v6, s[80:83], 0 offen sc1
  s_waitcnt vmcnt(1)
  v_cmp_gt_u32 vcc, 32, v129
  s_nop 3
  s_cbranch_vccz POLLD6
  s_add_u32 s56, s56, 1
  s_cmp_lt_u32 s56, 400000
  s_cbranch_scc1 POLL5
POLLD6:
  s_lshl_b32 s57, s44, 7
  s_add_u32 s57, s57, 6144
  s_cmp_eq_u32 s45, 0
  s_cselect_b32 s57, s57, 0x40000000
  v_mov_b32 v6, 0x40000000
  v_mov_b32 v5, s97
  v_writelane_b32 v6, s57, 0
  buffer_store_dword v5, v6, s[80:83], 0 offen sc1
X2W_SKIP:
  s_barrier
  s_add_u32 s8, s42, 0x240000
  s_addc_u32 s9, s43, 0
  s_mov_b32 s10, 0x210000
  s_mov_b32 s11, 0x20000
  s_add_u32 s12, s42, 0xf80000
  s_addc_u32 s13, s43, 0
  s_mov_b32 s14, 0x3000
  s_mov_b32 s15, 0x20000
  s_mov_b32 s58, 4224
  v_mul_u32_u24 v3, 8448, v0
  s_lshl_b32 s57, s46, 4
  v_add_u32 v3, s57, v3
  v_lshlrev_b32 v4, 3, v0
  buffer_load_dwordx4 v[16:19], v3, s[8:11], 0 offen sc1
  buffer_load_dwordx4 v[20:23], v3, s[8:11], s58 offen sc1
  s_mov_b32 s57, 0
  buffer_load_dwordx2 v[24:25], v4, s[12:15], s57 offen sc1
  s_mov_b32 s57, 2048
  buffer_load_dwordx2 v[26:27], v4, s[12:15], s57 offen sc1
  s_mov_b32 s57, 4096
  buffer_load_dwordx2 v[28:29], v4, s[12:15], s57 offen sc1
  s_mov_b32 s57, 6144
  buffer_load_dwordx2 v[30:31], v4, s[12:15], s57 offen sc1
  s_mov_b32 s57, 8192
  buffer_load_dwordx2 v[32:33], v4, s[12:15], s57 offen sc1
  s_waitcnt vmcnt(7)
  ds_read_b64_tr_b16 a[128:129], v251 offset:0
  ds_read_b64_tr_b16 a[130:131], v251 offset:512
  ds_read_b64_tr_b16 a[132:133], v252 offset:0
  ds_read_b64_tr_b16 a[134:135], v252 offset:512
  ds_read_b64_tr_b16 a[136:137], v253 offset:0
  ds_read_b64_tr_b16 a[138:139], v253 offset:512
  ds_read_b64_tr_b16 a[140:141], v254 offset:0
  ds_read_b64_tr_b16 a[142:143], v254 offset:512
  ds_read_b64_tr_b16 a[144:145], v251 offset:4096
  ds_read_b64_tr_b16 a[146:147], v251 offset:4608
  ds_read_b64_tr_b16 a[148:149], v252 offset:4096
  ds_read_b64_tr_b16 a[150:151], v252 offset:4608
  ds_read_b64_tr_b16 a[152:153], v253 offset:4096
  ds_read_b64_tr_b16 a[154:155], v253 offset:4608
  ds_read_b64_tr_b16 a[156:157], v254 offset:4096
  ds_read_b64_tr_b16 a[158:159], v254 offset:4608
  ds_read_b64_tr_b16 a[160:161], v251 offset:8192
  ds_read_b64_tr_b16 a[162:163], v251 offset:8704
  ds_read_b64_tr_b16 a[164:165], v252 offset:8192
  ds_read_b64_tr_b16 a[166:167], v252 offset:8704
  ds_read_b64_tr_b16 a[168:169], v253 offset:8192
  ds_read_b64_tr_b16 a[170:171], v253 offset:8704
  ds_read_b64_tr_b16 a[172:173], v254 offset:8192
  ds_read_b64_tr_b16 a[174:175], v254 offset:8704
  ds_read_b64_tr_b16 a[176:177], v251 offset:12288
  ds_read_b64_tr_b16 a[178:179], v251 offset:12800
  ds_read_b64_tr_b16 a[180:181], v252 offset:12288
  ds_read_b64_tr_b16 a[182:183], v252 offset:12800
  ds_read_b64_tr_b16 a[184:185], v253 offset:12288
  ds_read_b64_tr_b16 a[186:187], v253 offset:12800
  ds_read_b64_tr_b16 a[188:189], v254 offset:12288
  ds_read_b64_tr_b16 a[190:191], v254 offset:12800
  ds_read_b64_tr_b16 a[192:193], v251 offset:16384
  ds_read_b64_tr_b16 a[194:195], v251 offset:16896
  ds_read_b64_tr_b16 a[196:197], v252 offset:16384
  ds_read_b64_tr_b16 a[198:199], v252 offset:16896
  ds_read_b64_tr_b16 a[200:201], v253 offset:16384
  ds_read_b64_tr_b16 a[202:203], v253 offset:16896
  ds_read_b64_tr_b16 a[204:205], v254 offset:16384
  ds_read_b64_tr_b16 a[206:207], v254 offset:16896
  ds_read_b64_tr_b16 a[208:209], v251 offset:20480
  ds_read_b64_tr_b16 a[210:211], v251 offset:20992
  ds_read_b64_tr_b16 a[212:213], v252 offset:20480
  ds_read_b64_tr_b16 a[214:215], v252 offset:20992
  ds_read_b64_tr_b16 a[216:217], v253 offset:20480
  ds_read_b64_tr_b16 a[218:219], v253 offset:20992
  ds_read_b64_tr_b16 a[220:221], v254 offset:20480
  ds_read_b64_tr_b16 a[222:223], v254 offset:20992
  ds_read_b64_tr_b16 a[224:225], v251 offset:24576
  ds_read_b64_tr_b16 a[226:227], v251 offset:25088
  ds_read_b64_tr_b16 a[228:229], v252 offset:24576
  ds_read_b64_tr_b16 a[230:231], v252 offset:25088
  ds_read_b64_tr_b16 a[232:233], v253 offset:24576
  ds_read_b64_tr_b16 a[234:235], v253 offset:25088
  ds_read_b64_tr_b16 a[236:237], v254 offset:24576
  ds_read_b64_tr_b16 a[238:239], v254 offset:25088
  s_waitcnt vmcnt(0)
  v_cvt_pk_bf16_f32 v24, 0, v24
  v_cvt_pk_bf16_f32 v25, 0, v25
  v_cvt_pk_bf16_f32 v26, 0, v26
  v_cvt_pk_bf16_f32 v27, 0, v27
  v_cvt_pk_bf16_f32 v28, 0, v28
  v_cvt_pk_bf16_f32 v29, 0, v29
  v_cvt_pk_bf16_f32 v30, 0, v30
  v_cvt_pk_bf16_f32 v31, 0, v31
  v_cvt_pk_bf16_f32 v32, 0, v32
  v_cvt_pk_bf16_f32 v33, 0, v33
  v_add_f32 v26, 1.0, v26
  v_add_f32 v27, 1.0, v27
  v_add_f32 v32, 1.0, v32
  v_add_f32 v33, 1.0, v33
  v_cvt_pk_bf16_f32 v26, 0, v26
  v_cvt_pk_bf16_f32 v27, 0, v27
  v_cvt_pk_bf16_f32 v32, 0, v32
  v_cvt_pk_bf16_f32 v33, 0, v33
  v_lshlrev_b32 v96, 16, v16
  v_and_b32 v98, 0xffff0000, v16
  v_lshlrev_b32 v97, 16, v20
  v_and_b32 v99, 0xffff0000, v20
  v_lshlrev_b32 v100, 16, v17
  v_and_b32 v102, 0xffff0000, v17
  v_lshlrev_b32 v101, 16, v21
  v_and_b32 v103, 0xffff0000, v21
  v_lshlrev_b32 v104, 16, v18
  v_and_b32 v106, 0xffff0000, v18
  v_lshlrev_b32 v105, 16, v22
  v_and_b32 v107, 0xffff0000, v22
  v_lshlrev_b32 v108, 16, v19
  v_and_b32 v110, 0xffff0000, v19
  v_lshlrev_b32 v109, 16, v23
  v_and_b32 v111, 0xffff0000, v23
  v_pk_mul_f32 v[112:113], v[112:113], v[26:27]
  v_pk_mul_f32 v[114:115], v[114:115], v[26:27]
  v_pk_mul_f32 v[116:117], v[116:117], v[26:27]
  v_pk_mul_f32 v[118:119], v[118:119], v[26:27]
  v_pk_mul_f32 v[120:121], v[120:121], v[26:27]
  v_pk_mul_f32 v[122:123], v[122:123], v[26:27]
  v_pk_mul_f32 v[124:125], v[124:125], v[26:27]
  v_pk_mul_f32 v[126:127], v[126:127], v[26:27]
  v_cvt_pk_bf16_f32 v112, 0, v112
  v_cvt_pk_bf16_f32 v113, 0, v113
  v_cvt_pk_bf16_f32 v114, 0, v114
  v_cvt_pk_bf16_f32 v115, 0, v115
  v_cvt_pk_bf16_f32 v116, 0, v116
  v_cvt_pk_bf16_f32 v117, 0, v117
  v_cvt_pk_bf16_f32 v118, 0, v118
  v_cvt_pk_bf16_f32 v119, 0, v119
  v_cvt_pk_bf16_f32 v120, 0, v120
  v_cvt_pk_bf16_f32 v121, 0, v121
  v_cvt_pk_bf16_f32 v122, 0, v122
  v_cvt_pk_bf16_f32 v123, 0, v123
  v_cvt_pk_bf16_f32 v124, 0, v124
  v_cvt_pk_bf16_f32 v125, 0, v125
  v_cvt_pk_bf16_f32 v126, 0, v126
  v_cvt_pk_bf16_f32 v127, 0, v127
  v_pk_add_f32 v[112:113], v[112:113], v[24:25]
  v_pk_add_f32 v[114:115], v[114:115], v[24:25]
  v_pk_add_f32 v[116:117], v[116:117], v[24:25]
  v_pk_add_f32 v[118:119], v[118:119], v[24:25]
  v_pk_add_f32 v[120:121], v[120:121], v[24:25]
  v_pk_add_f32 v[122:123], v[122:123], v[24:25]
  v_pk_add_f32 v[124:125], v[124:125], v[24:25]
  v_pk_add_f32 v[126:127], v[126:127], v[24:25]
  v_cvt_pk_bf16_f32 v112, 0, v112
  v_cvt_pk_bf16_f32 v113, 0, v113
  v_cvt_pk_bf16_f32 v114, 0, v114
  v_cvt_pk_bf16_f32 v115, 0, v115
  v_cvt_pk_bf16_f32 v116, 0, v116
  v_cvt_pk_bf16_f32 v117, 0, v117
  v_cvt_pk_bf16_f32 v118, 0, v118
  v_cvt_pk_bf16_f32 v119, 0, v119
  v_cvt_pk_bf16_f32 v120, 0, v120
  v_cvt_pk_bf16_f32 v121, 0, v121
  v_cvt_pk_bf16_f32 v122, 0, v122
  v_cvt_pk_bf16_f32 v123, 0, v123
  v_cvt_pk_bf16_f32 v124, 0, v124
  v_cvt_pk_bf16_f32 v125, 0, v125
  v_cvt_pk_bf16_f32 v126, 0, v126
  v_cvt_pk_bf16_f32 v127, 0, v127
  v_pk_mul_f32 v[112:113], v[112:113], v[96:97]
  v_pk_mul_f32 v[114:115], v[114:115], v[98:99]
  v_pk_mul_f32 v[116:117], v[116:117], v[100:101]
  v_pk_mul_f32 v[118:119], v[118:119], v[102:103]
  v_pk_mul_f32 v[120:121], v[120:121], v[104:105]
  v_pk_mul_f32 v[122:123], v[122:123], v[106:107]
  v_pk_mul_f32 v[124:125], v[124:125], v[108:109]
  v_pk_mul_f32 v[126:127], v[126:127], v[110:111]
  v_cvt_pk_bf16_f32 v112, 0, v112
  v_cvt_pk_bf16_f32 v113, 0, v113
  v_cvt_pk_bf16_f32 v114, 0, v114
  v_cvt_pk_bf16_f32 v115, 0, v115
  v_cvt_pk_bf16_f32 v116, 0, v116
  v_cvt_pk_bf16_f32 v117, 0, v117
  v_cvt_pk_bf16_f32 v118, 0, v118
  v_cvt_pk_bf16_f32 v119, 0, v119
  v_cvt_pk_bf16_f32 v120, 0, v120
  v_cvt_pk_bf16_f32 v121, 0, v121
  v_cvt_pk_bf16_f32 v122, 0, v122
  v_cvt_pk_bf16_f32 v123, 0, v123
  v_cvt_pk_bf16_f32 v124, 0, v124
  v_cvt_pk_bf16_f32 v125, 0, v125
  v_cvt_pk_bf16_f32 v126, 0, v126
  v_cvt_pk_bf16_f32 v127, 0, v127
  v_pk_mul_f32 v[112:113], v[112:113], v[28:29]
  v_pk_mul_f32 v[114:115], v[114:115], v[28:29]
  v_pk_mul_f32 v[116:117], v[116:117], v[28:29]
  v_pk_mul_f32 v[118:119], v[118:119], v[28:29]
  v_pk_mul_f32 v[120:121], v[120:121], v[28:29]
  v_pk_mul_f32 v[122:123], v[122:123], v[28:29]
  v_pk_mul_f32 v[124:125], v[124:125], v[28:29]
  v_pk_mul_f32 v[126:127], v[126:127], v[28:29]
  v_cvt_pk_bf16_f32 v112, 0, v112
  v_cvt_pk_bf16_f32 v113, 0, v113
  v_cvt_pk_bf16_f32 v114, 0, v114
  v_cvt_pk_bf16_f32 v115, 0, v115
  v_cvt_pk_bf16_f32 v116, 0, v116
  v_cvt_pk_bf16_f32 v117, 0, v117
  v_cvt_pk_bf16_f32 v118, 0, v118
  v_cvt_pk_bf16_f32 v119, 0, v119
  v_cvt_pk_bf16_f32 v120, 0, v120
  v_cvt_pk_bf16_f32 v121, 0, v121
  v_cvt_pk_bf16_f32 v122, 0, v122
  v_cvt_pk_bf16_f32 v123, 0, v123
  v_cvt_pk_bf16_f32 v124, 0, v124
  v_cvt_pk_bf16_f32 v125, 0, v125
  v_cvt_pk_bf16_f32 v126, 0, v126
  v_cvt_pk_bf16_f32 v127, 0, v127
  v_pk_add_f32 v[40:41], v[40:41], v[112:113]
  v_pk_add_f32 v[42:43], v[42:43], v[114:115]
  v_pk_add_f32 v[44:45], v[44:45], v[116:117]
  v_pk_add_f32 v[46:47], v[46:47], v[118:119]
  v_pk_add_f32 v[48:49], v[48:49], v[120:121]
  v_pk_add_f32 v[50:51], v[50:51], v[122:123]
  v_pk_add_f32 v[52:53], v[52:53], v[124:125]
  v_pk_add_f32 v[54:55], v[54:55], v[126:127]
  s_add_u32 s4, s42, 0x480000
  s_addc_u32 s5, s43, 0
  s_mov_b32 s6, 0x200000
  s_mov_b32 s7, 0x20000
  v_cvt_pk_bf16_f32 v8, v40, v41
  v_cvt_pk_bf16_f32 v9, v42, v43
  v_cvt_pk_bf16_f32 v10, v44, v45
  v_cvt_pk_bf16_f32 v11, v46, v47
  v_cvt_pk_bf16_f32 v12, v48, v49
  v_cvt_pk_bf16_f32 v13, v50, v51
  v_cvt_pk_bf16_f32 v14, v52, v53
  v_cvt_pk_bf16_f32 v15, v54, v55
  s_mul_i32 s57, s3, 2560
  s_add_u32 s57, s57, 139264
  v_lshlrev_b32 v34, 2, v1
  v_add_u32 v34, s57, v34
  ds_write_b32 v34, v8 offset:0
  ds_write_b32 v34, v9 offset:256
  ds_write_b32 v34, v10 offset:512
  ds_write_b32 v34, v11 offset:768
  ds_write_b32 v34, v12 offset:1024
  ds_write_b32 v34, v13 offset:1280
  ds_write_b32 v34, v14 offset:1536
  ds_write_b32 v34, v15 offset:1792
  v_lshrrev_b32 v35, 4, v1
  v_and_b32 v36, 15, v1
  v_lshlrev_b32 v37, 8, v35
  v_lshl_add_u32 v37, v36, 4, v37
  v_add_u32 v37, s57, v37
  v_lshlrev_b32 v38, 10, v35
  v_lshl_add_u32 v38, v36, 4, v38
  s_lshl_b32 s58, s46, 13
  s_lshl_b32 s59, s3, 8
  s_add_u32 s58, s58, s59
  v_add_u32 v38, s58, v38
  v_lshlrev_b32 v40, 16, v8
  v_and_b32 v41, 0xffff0000, v8
  v_lshlrev_b32 v42, 16, v9
  v_and_b32 v43, 0xffff0000, v9
  v_lshlrev_b32 v44, 16, v10
  v_and_b32 v45, 0xffff0000, v10
  v_lshlrev_b32 v46, 16, v11
  v_and_b32 v47, 0xffff0000, v11
  v_lshlrev_b32 v48, 16, v12
  v_and_b32 v49, 0xffff0000, v12
  v_lshlrev_b32 v50, 16, v13
  v_and_b32 v51, 0xffff0000, v13
  v_lshlrev_b32 v52, 16, v14
  v_and_b32 v53, 0xffff0000, v14
  v_lshlrev_b32 v54, 16, v15
  v_and_b32 v55, 0xffff0000, v15
  v_add_f32 v56, v40, v41
  v_mul_f32 v64, v40, v40
  v_add_f32 v57, v42, v43
  v_mul_f32 v65, v42, v42
  v_add_f32 v58, v44, v45
  v_mul_f32 v66, v44, v44
  v_add_f32 v59, v46, v47
  v_mul_f32 v67, v46, v46
  v_add_f32 v60, v48, v49
  v_mul_f32 v68, v48, v48
  v_add_f32 v61, v50, v51
  v_mul_f32 v69, v50, v50
  v_add_f32 v62, v52, v53
  v_mul_f32 v70, v52, v52
  v_add_f32 v63, v54, v55
  v_mul_f32 v71, v54, v54
  v_fmac_f32 v64, v41, v41
  v_fmac_f32 v65, v43, v43
  v_fmac_f32 v66, v45, v45
  v_fmac_f32 v67, v47, v47
  v_fmac_f32 v68, v49, v49
  v_fmac_f32 v69, v51, v51
  v_fmac_f32 v70, v53, v53
  v_fmac_f32 v71, v55, v55
  v_and_b32 v72, 1, v1
  v_cmp_eq_u32 vcc, 1, v72
  s_nop 1
  v_cndmask_b32 v73, v57, v56, vcc
  v_cndmask_b32 v74, v59, v58, vcc
  v_cndmask_b32 v75, v61, v60, vcc
  v_cndmask_b32 v76, v63, v62, vcc
  v_cndmask_b32 v56, v56, v57, vcc
  v_cndmask_b32 v58, v58, v59, vcc
  v_cndmask_b32 v60, v60, v61, vcc
  v_cndmask_b32 v62, v62, v63, vcc
  v_add_f32_dpp v56, v73, v56 quad_perm:[1,0,3,2] row_mask:0xf bank_mask:0xf
  v_add_f32_dpp v58, v74, v58 quad_perm:[1,0,3,2] row_mask:0xf bank_mask:0xf
  v_add_f32_dpp v60, v75, v60 quad_perm:[1,0,3,2] row_mask:0xf bank_mask:0xf
  v_add_f32_dpp v62, v76, v62 quad_perm:[1,0,3,2] row_mask:0xf bank_mask:0xf
  v_and_b32 v72, 1, v1
  v_cmp_eq_u32 vcc, 1, v72
  s_nop 1
  v_cndmask_b32 v73, v65, v64, vcc
  v_cndmask_b32 v74, v67, v66, vcc
  v_cndmask_b32 v75, v69, v68, vcc
  v_cndmask_b32 v76, v71, v70, vcc
  v_cndmask_b32 v64, v64, v65, vcc
  v_cndmask_b32 v66, v66, v67, vcc
  v_cndmask_b32 v68, v68, v69, vcc
  v_cndmask_b32 v70, v70, v71, vcc
  v_add_f32_dpp v64, v73, v64 quad_perm:[1,0,3,2] row_mask:0xf bank_mask:0xf
  v_add_f32_dpp v66, v74, v66 quad_perm:[1,0,3,2] row_mask:0xf bank_mask:0xf
  v_add_f32_dpp v68, v75, v68 quad_perm:[1,0,3,2] row_mask:0xf bank_mask:0xf
  v_add_f32_dpp v70, v76, v70 quad_perm:[1,0,3,2] row_mask:0xf bank_mask:0xf
  v_and_b32 v72, 2, v1
  v_cmp_eq_u32 vcc, 2, v72
  s_nop 1
  v_cndmask_b32 v73, v58, v56, vcc
  v_cndmask_b32 v74, v62, v60, vcc
  v_cndmask_b32 v75, v66, v64, vcc
  v_cndmask_b32 v76, v70, v68, vcc
  v_cndmask_b32 v56, v56, v58, vcc
  v_cndmask_b32 v60, v60, v62, vcc
  v_cndmask_b32 v64, v64, v66, vcc
  v_cndmask_b32 v68, v68, v70, vcc
  v_add_f32_dpp v56, v73, v56 quad_perm:[2,3,0,1] row_mask:0xf bank_mask:0xf
  v_add_f32_dpp v60, v74, v60 quad_perm:[2,3,0,1] row_mask:0xf bank_mask:0xf
  v_add_f32_dpp v64, v75, v64 quad_perm:[2,3,0,1] row_mask:0xf bank_mask:0xf
  v_add_f32_dpp v68, v76, v68 quad_perm:[2,3,0,1] row_mask:0xf bank_mask:0xf
  v_and_b32 v72, 4, v1
  v_cmp_eq_u32 vcc, 4, v72
  s_nop 1
  v_cndmask_b32 v73, v60, v56, vcc
  v_cndmask_b32 v74, v68, v64, vcc
  v_cndmask_b32 v56, v56, v60, vcc
  v_cndmask_b32 v64, v64, v68, vcc
  v_mov_b32_dpp v75, v73 row_half_mirror row_mask:0xf bank_mask:0xf
  v_mov_b32_dpp v76, v74 row_half_mirror row_mask:0xf bank_mask:0xf
  s_nop 0
  v_add_f32_dpp v56, v75, v56 quad_perm:[3,2,1,0] row_mask:0xf bank_mask:0xf
  v_add_f32_dpp v64, v76, v64 quad_perm:[3,2,1,0] row_mask:0xf bank_mask:0xf
  s_nop 0
  v_add_f32_dpp v56, v56, v56 row_ror:8 row_mask:0xf bank_mask:0xf
  v_add_f32_dpp v64, v64, v64 row_ror:8 row_mask:0xf bank_mask:0xf
  v_mov_b32 v72, v56
  v_mov_b32 v73, v64
  s_nop 0
  v_permlane16_swap_b32 v72, v56
  v_permlane16_swap_b32 v73, v64
  v_add_f32 v56, v56, v72
  v_add_f32 v64, v64, v73
  v_mov_b32 v72, v56
  v_mov_b32 v73, v64
  s_nop 0
  v_permlane32_swap_b32 v72, v56
  v_permlane32_swap_b32 v73, v64
  v_add_f32 v56, v56, v72
  v_add_f32 v64, v64, v73
  v_and_b32 v72, 7, v1
  v_lshlrev_b32 v72, 3, v72
  s_lshl_b32 s56, s3, 6
  s_add_u32 s56, s56, 135680
  v_add_u32 v73, s56, v72
  v_mov_b32 v58, v56
  v_mov_b32 v59, v64
  ds_write_b64 v73, v[58:59]
  v_add_u32 v72, 135680, v72
  ds_read_b128 v[128:131], v37
  ds_read_b128 v[132:135], v37 offset:1024
  s_waitcnt lgkmcnt(0)
  buffer_store_dwordx4 v[128:131], v38, s[4:7], 0 offen sc1
  buffer_store_dwordx4 v[132:135], v38, s[4:7], s62 offen sc1
  s_waitcnt lgkmcnt(0)
  s_barrier
  ds_read_b64 v[60:61], v72 offset:0
  ds_read_b64 v[62:63], v72 offset:64
  ds_read_b64 v[64:65], v72 offset:128
  ds_read_b64 v[66:67], v72 offset:192
  s_waitcnt lgkmcnt(0)
  v_add_f32 v60, v60, v62
  v_add_f32 v61, v61, v63
  v_add_f32 v64, v64, v66
  v_add_f32 v65, v65, v67
  v_add_f32 v60, v60, v64
  v_add_f32 v61, v61, v65
  v_mul_f32 v60, 0x3b000000, v60
  v_mul_f32 v61, 0x3b000000, v61
  v_fma_f32 v61, -v60, v60, v61
  v_max_f32 v61, 0, v61
  v_cvt_pk_bf16_f32 v60, 0, v60
  v_cvt_pk_bf16_f32 v61, 0, v61
  v_add_f32 v61, 0x3727c5ac, v61
  v_cvt_pk_bf16_f32 v61, 0, v61
  v_sqrt_f32 v61, v61
  s_nop 0
  v_cvt_pk_bf16_f32 v61, 0, v61
  v_rcp_f32 v61, v61
  v_readlane_b32 s64, v60, 0
  v_readlane_b32 s65, v60, 1
  v_readlane_b32 s66, v60, 2
  v_readlane_b32 s67, v60, 3
  v_readlane_b32 s68, v60, 4
  v_readlane_b32 s69, v60, 5
  v_readlane_b32 s70, v60, 6
  v_readlane_b32 s71, v60, 7
  v_readlane_b32 s72, v61, 0
  v_readlane_b32 s73, v61, 1
  v_readlane_b32 s74, v61, 2
  v_readlane_b32 s75, v61, 3
  v_readlane_b32 s76, v61, 4
  v_readlane_b32 s77, v61, 5
  v_readlane_b32 s78, v61, 6
  v_readlane_b32 s79, v61, 7
  v_pk_add_f32 v[112:113], v[40:41], s[64:65] op_sel_hi:[1,0] neg_lo:[0,1] neg_hi:[0,1]
  v_pk_add_f32 v[114:115], v[42:43], s[64:65] op_sel:[0,1] neg_lo:[0,1] neg_hi:[0,1]
  v_pk_add_f32 v[116:117], v[44:45], s[66:67] op_sel_hi:[1,0] neg_lo:[0,1] neg_hi:[0,1]
  v_pk_add_f32 v[118:119], v[46:47], s[66:67] op_sel:[0,1] neg_lo:[0,1] neg_hi:[0,1]
  v_pk_add_f32 v[120:121], v[48:49], s[68:69] op_sel_hi:[1,0] neg_lo:[0,1] neg_hi:[0,1]
  v_pk_add_f32 v[122:123], v[50:51], s[68:69] op_sel:[0,1] neg_lo:[0,1] neg_hi:[0,1]
  v_pk_add_f32 v[124:125], v[52:53], s[70:71] op_sel_hi:[1,0] neg_lo:[0,1] neg_hi:[0,1]
  v_pk_add_f32 v[126:127], v[54:55], s[70:71] op_sel:[0,1] neg_lo:[0,1] neg_hi:[0,1]
  v_cvt_pk_bf16_f32 v112, 0, v112
  v_cvt_pk_bf16_f32 v113, 0, v113
  v_cvt_pk_bf16_f32 v114, 0, v114
  v_cvt_pk_bf16_f32 v115, 0, v115
  v_cvt_pk_bf16_f32 v116, 0, v116
  v_cvt_pk_bf16_f32 v117, 0, v117
  v_cvt_pk_bf16_f32 v118, 0, v118
  v_cvt_pk_bf16_f32 v119, 0, v119
  v_cvt_pk_bf16_f32 v120, 0, v120
  v_cvt_pk_bf16_f32 v121, 0, v121
  v_cvt_pk_bf16_f32 v122, 0, v122
  v_cvt_pk_bf16_f32 v123, 0, v123
  v_cvt_pk_bf16_f32 v124, 0, v124
  v_cvt_pk_bf16_f32 v125, 0, v125
  v_cvt_pk_bf16_f32 v126, 0, v126
  v_cvt_pk_bf16_f32 v127, 0, v127
  v_pk_mul_f32 v[112:113], v[112:113], s[72:73] op_sel_hi:[1,0]
  v_pk_mul_f32 v[114:115], v[114:115], s[72:73] op_sel:[0,1]
  v_pk_mul_f32 v[116:117], v[116:117], s[74:75] op_sel_hi:[1,0]
  v_pk_mul_f32 v[118:119], v[118:119], s[74:75] op_sel:[0,1]
  v_pk_mul_f32 v[120:121], v[120:121], s[76:77] op_sel_hi:[1,0]
  v_pk_mul_f32 v[122:123], v[122:123], s[76:77] op_sel:[0,1]
  v_pk_mul_f32 v[124:125], v[124:125], s[78:79] op_sel_hi:[1,0]
  v_pk_mul_f32 v[126:127], v[126:127], s[78:79] op_sel:[0,1]
  v_cvt_pk_bf16_f32 v112, 0, v112
  v_cvt_pk_bf16_f32 v113, 0, v113
  v_cvt_pk_bf16_f32 v114, 0, v114
  v_cvt_pk_bf16_f32 v115, 0, v115
  v_cvt_pk_bf16_f32 v116, 0, v116
  v_cvt_pk_bf16_f32 v117, 0, v117
  v_cvt_pk_bf16_f32 v118, 0, v118
  v_cvt_pk_bf16_f32 v119, 0, v119
  v_cvt_pk_bf16_f32 v120, 0, v120
  v_cvt_pk_bf16_f32 v121, 0, v121
  v_cvt_pk_bf16_f32 v122, 0, v122
  v_cvt_pk_bf16_f32 v123, 0, v123
  v_cvt_pk_bf16_f32 v124, 0, v124
  v_cvt_pk_bf16_f32 v125, 0, v125
  v_cvt_pk_bf16_f32 v126, 0, v126
  v_cvt_pk_bf16_f32 v127, 0, v127
  v_pk_mul_f32 v[112:113], v[112:113], v[32:33]
  v_pk_mul_f32 v[114:115], v[114:115], v[32:33]
  v_pk_mul_f32 v[116:117], v[116:117], v[32:33]
  v_pk_mul_f32 v[118:119], v[118:119], v[32:33]
  v_pk_mul_f32 v[120:121], v[120:121], v[32:33]
  v_pk_mul_f32 v[122:123], v[122:123], v[32:33]
  v_pk_mul_f32 v[124:125], v[124:125], v[32:33]
  v_pk_mul_f32 v[126:127], v[126:127], v[32:33]
  v_cvt_pk_bf16_f32 v112, 0, v112
  v_cvt_pk_bf16_f32 v113, 0, v113
  v_cvt_pk_bf16_f32 v114, 0, v114
  v_cvt_pk_bf16_f32 v115, 0, v115
  v_cvt_pk_bf16_f32 v116, 0, v116
  v_cvt_pk_bf16_f32 v117, 0, v117
  v_cvt_pk_bf16_f32 v118, 0, v118
  v_cvt_pk_bf16_f32 v119, 0, v119
  v_cvt_pk_bf16_f32 v120, 0, v120
  v_cvt_pk_bf16_f32 v121, 0, v121
  v_cvt_pk_bf16_f32 v122, 0, v122
  v_cvt_pk_bf16_f32 v123, 0, v123
  v_cvt_pk_bf16_f32 v124, 0, v124
  v_cvt_pk_bf16_f32 v125, 0, v125
  v_cvt_pk_bf16_f32 v126, 0, v126
  v_cvt_pk_bf16_f32 v127, 0, v127
  v_pk_add_f32 v[112:113], v[112:113], v[30:31]
  v_pk_add_f32 v[114:115], v[114:115], v[30:31]
  v_pk_add_f32 v[116:117], v[116:117], v[30:31]
  v_pk_add_f32 v[118:119], v[118:119], v[30:31]
  v_pk_add_f32 v[120:121], v[120:121], v[30:31]
  v_pk_add_f32 v[122:123], v[122:123], v[30:31]
  v_pk_add_f32 v[124:125], v[124:125], v[30:31]
  v_pk_add_f32 v[126:127], v[126:127], v[30:31]
  v_cvt_pk_bf16_f32 v96, v112, v113
  v_cvt_pk_bf16_f32 v97, v114, v115
  v_cvt_pk_bf16_f32 v98, v116, v117
  v_cvt_pk_bf16_f32 v99, v118, v119
  v_cvt_pk_bf16_f32 v100, v120, v121
  v_cvt_pk_bf16_f32 v101, v122, v123
  v_cvt_pk_bf16_f32 v102, v124, v125
  v_cvt_pk_bf16_f32 v103, v126, v127
  s_add_u32 s4, s42, 0x680000
  s_addc_u32 s5, s43, 0
  s_mov_b32 s6, 0x200000
  s_mov_b32 s7, 0x20000
  ds_write_b32 v34, v96 offset:0
  ds_write_b32 v34, v97 offset:320
  ds_write_b32 v34, v98 offset:640
  ds_write_b32 v34, v99 offset:960
  ds_write_b32 v34, v100 offset:1280
  ds_write_b32 v34, v101 offset:1600
  ds_write_b32 v34, v102 offset:1920
  ds_write_b32 v34, v103 offset:2240
  s_mul_i32 s57, s3, 2560
  s_add_u32 s57, s57, 139264
  v_and_b32 v35, 7, v1
  v_lshrrev_b32 v36, 3, v1
  v_mul_u32_u24 v37, 320, v35
  v_lshrrev_b32 v39, 2, v36
  v_and_b32 v36, 3, v36
  v_lshl_add_u32 v37, v39, 6, v37
  v_lshl_add_u32 v37, v36, 3, v37
  v_add_u32 v37, s57, v37
  v_lshlrev_b32 v38, 10, v39
  v_lshl_add_u32 v38, v36, 8, v38
  v_lshl_add_u32 v38, v35, 4, v38
  s_lshr_b32 s58, s46, 1
  s_lshl_b32 s58, s58, 14
  s_and_b32 s59, s46, 1
  s_lshl_b32 s59, s59, 7
  s_add_u32 s58, s58, s59
  s_lshl_b32 s59, s3, 12
  s_add_u32 s58, s58, s59
  v_add_u32 v38, s58, v38
  s_waitcnt lgkmcnt(0)
  ds_read_b64 v[128:129], v37
  ds_read_b64 v[130:131], v37 offset:32
  ds_read_b64 v[132:133], v37 offset:128
  ds_read_b64 v[134:135], v37 offset:160
  s_waitcnt lgkmcnt(0)
  buffer_store_dwordx4 v[128:131], v38, s[4:7], 0 offen sc1
  buffer_store_dwordx4 v[132:135], v38, s[4:7], 0 offen offset:2048 sc1
  s_waitcnt vmcnt(0)
  s_barrier
  s_cmp_lg_u32 s3, 0
  s_cbranch_scc1 X3_MID
  s_lshr_b32 s57, s46, 4
  s_and_b32 s58, s46, 15
  s_lshl_b32 s57, s57, 7
  s_lshl_b32 s58, s58, 2
  s_add_u32 s58, s58, s57
  s_add_u32 s58, s58, 2048
  v_mov_b32 v4, 0x40000000
  v_mov_b32 v5, 1
  v_writelane_b32 v4, s58, 0
  buffer_store_dword v5, v4, s[80:83], 0 offen sc1
X3_MID:
  s_mov_b32 s100, 0
  s_add_u32 m0, s86, 0
  s_nop 0
  buffer_load_dwordx4 v240, s[88:91], s100 offen offset:0 lds
  buffer_load_dwordx4 v241, s[88:91], s100 offen offset:1024 lds
  buffer_load_dwordx4 v242, s[88:91], s100 offen offset:2048 lds
  buffer_load_dwordx4 v243, s[88:91], s100 offen offset:3072 lds
  s_mov_b32 s100, 229376
  s_add_u32 m0, s86, 16384
  s_nop 0
  buffer_load_dwordx4 v240, s[88:91], s100 offen offset:0 lds
  buffer_load_dwordx4 v241, s[88:91], s100 offen offset:1024 lds
  buffer_load_dwordx4 v242, s[88:91], s100 offen offset:2048 lds
  buffer_load_dwordx4 v243, s[88:91], s100 offen offset:3072 lds
  s_mov_b32 s100, 458752
  s_add_u32 m0, s86, 32768
  s_nop 0
  buffer_load_dwordx4 v240, s[88:91], s100 offen offset:0 lds
  buffer_load_dwordx4 v241, s[88:91], s100 offen offset:1024 lds
  buffer_load_dwordx4 v242, s[88:91], s100 offen offset:2048 lds
  buffer_load_dwordx4 v243, s[88:91], s100 offen offset:3072 lds
  s_mov_b32 s100, 688128
  s_add_u32 m0, s86, 49152
  s_nop 0
  buffer_load_dwordx4 v240, s[88:91], s100 offen offset:0 lds
  buffer_load_dwordx4 v241, s[88:91], s100 offen offset:1024 lds
  buffer_load_dwordx4 v242, s[88:91], s100 offen offset:2048 lds
  buffer_load_dwordx4 v243, s[88:91], s100 offen offset:3072 lds
  s_mov_b32 s100, 917504
  s_add_u32 m0, s86, 65536
  s_nop 0
  buffer_load_dwordx4 v240, s[88:91], s100 offen offset:0 lds
  buffer_load_dwordx4 v241, s[88:91], s100 offen offset:1024 lds
  buffer_load_dwordx4 v242, s[88:91], s100 offen offset:2048 lds
  buffer_load_dwordx4 v243, s[88:91], s100 offen offset:3072 lds
  s_mov_b32 s100, 1146880
  s_add_u32 m0, s86, 81920
  s_nop 0
  buffer_load_dwordx4 v240, s[88:91], s100 offen offset:0 lds
  buffer_load_dwordx4 v241, s[88:91], s100 offen offset:1024 lds
  buffer_load_dwordx4 v242, s[88:91], s100 offen offset:2048 lds
  buffer_load_dwordx4 v243, s[88:91], s100 offen offset:3072 lds
  s_mov_b32 s100, 1376256
  s_add_u32 m0, s86, 98304
  s_nop 0
  buffer_load_dwordx4 v240, s[88:91], s100 offen offset:0 lds
  buffer_load_dwordx4 v241, s[88:91], s100 offen offset:1024 lds
  buffer_load_dwordx4 v242, s[88:91], s100 offen offset:2048 lds
  buffer_load_dwordx4 v243, s[88:91], s100 offen offset:3072 lds
  s_mov_b32 s100, 1605632
  s_add_u32 m0, s86, 114688
  s_nop 0
  buffer_load_dwordx4 v240, s[88:91], s100 offen offset:0 lds
  buffer_load_dwordx4 v241, s[88:91], s100 offen offset:1024 lds
  buffer_load_dwordx4 v242, s[88:91], s100 offen offset:2048 lds
  buffer_load_dwordx4 v243, s[88:91], s100 offen offset:3072 lds
  s_cmp_lg_u32 s3, 0
  s_cbranch_scc1 X3_SKIP
  s_mov_b32 s57, s47
  s_lshl_b32 s57, s57, 7
  s_add_u32 s57, s57, 2048
  v_and_b32 v6, 15, v1
  v_lshlrev_b32 v6, 2, v6
  v_add_u32 v6, s57, v6
  s_mov_b32 s56, 0
  buffer_load_dword v128, v6, s[80:83], 0 offen sc1
POLL7:
  buffer_load_dword v129, v6, s[80:83], 0 offen sc1
  s_waitcnt vmcnt(1)
  v_cmp_gt_u32 vcc, 1, v128
  s_nop 3
  s_cbranch_vccz POLLD8
  buffer_load_dword v128, v6, s[80:83], 0 offen sc1
  s_waitcnt vmcnt(1)
  v_cmp_gt_u32 vcc, 1, v129
  s_nop 3
  s_cbranch_vccz POLLD8
  s_add_u32 s56, s56, 1
  s_cmp_lt_u32 s56, 400000
  s_cbranch_scc1 POLL7
POLLD8:
  s_branch X3_GO
X3_SKIP:
  s_waitcnt vmcnt(0)
X3_GO:
  s_barrier
  s_mov_b32 s70, s47
  s_mov_b32 s71, s63
  s_add_u32 s48, s42, 0x680000
  s_addc_u32 s49, s43, 0
  s_mov_b32 s50, 0x200000
  s_mov_b32 s51, 0x20000
  s_lshl_b32 s56, s70, 3
  s_lshl_b32 s57, s3, 1
  s_add_u32 s56, s56, s57
  s_lshl_b32 s56, s56, 14
  v_lshlrev_b32 v16, 4, v1
  v_add_u32 v16, s56, v16
  v_add_u32 v19, 0x4000, v16
  s_mov_b32 s101, 0
  buffer_load_dwordx4 a[0:3], v16, s[48:51], s101 offen offset:0 sc1
  buffer_load_dwordx4 a[4:7], v19, s[48:51], s101 offen offset:0 sc1
  buffer_load_dwordx4 a[8:11], v16, s[48:51], s101 offen offset:1024 sc1
  buffer_load_dwordx4 a[12:15], v19, s[48:51], s101 offen offset:1024 sc1
  s_mov_b32 s101, 2048
  buffer_load_dwordx4 a[16:19], v16, s[48:51], s101 offen offset:0 sc1
  buffer_load_dwordx4 a[20:23], v19, s[48:51], s101 offen offset:0 sc1
  buffer_load_dwordx4 a[24:27], v16, s[48:51], s101 offen offset:1024 sc1
  buffer_load_dwordx4 a[28:31], v19, s[48:51], s101 offen offset:1024 sc1
  s_lshl_b32 s75, s3, 14
  s_add_u32 s74, s75, 65536
  s_mul_i32 s59, s63, 96
  s_add_u32 s59, s59, 2048
  s_lshl_b32 s56, s63, 7
  s_sub_u32 s59, s59, s56
  v_lshrrev_b32 v4, 4, v1
  v_lshlrev_b32 v4, 1, v4
  v_and_b32 v5, 7, v1
  v_xor_b32 v4, v4, v5
  v_add_u32 v5, s59, v240
  v_mov_b32 v6, 0x40000000
  v_cmp_gt_u32 vcc, 6, v4
  s_nop 1
  v_cndmask_b32 v12, v6, v5, vcc
  v_add_u32 v13, 27648, v12
  v_add_u32 v17, 27648, v13
  v_add_u32 v18, 27648, v17
  v_lshlrev_b32 v14, 4, v1
  v_add_u32 v14, 94208, v14
  v_lshrrev_b32 v3, 4, v1
  v_bfe_u32 v5, v1, 2, 2
  v_lshl_add_u32 v4, v3, 2, v5
  v_and_b32 v6, 3, v1
  v_lshlrev_b32 v7, 7, v4
  v_lshl_add_u32 v7, v6, 3, v7
  v_lshrrev_b32 v5, 1, v5
  v_lshl_add_u32 v5, v3, 1, v5
  v_and_b32 v5, 3, v5
  v_lshlrev_b32 v5, 1, v5
  v_xor_b32 v6, 0, v5
  v_lshl_add_u32 v8, v6, 4, v7
  v_xor_b32 v6, 2, v5
  v_lshl_add_u32 v9, v6, 4, v7
  v_xor_b32 v6, 4, v5
  v_lshl_add_u32 v10, v6, 4, v7
  v_xor_b32 v6, 6, v5
  v_lshl_add_u32 v11, v6, 4, v7
  s_add_u32 s4, s42, 0x880000
  s_addc_u32 s5, s43, 0
  s_mov_b32 s6, 0x700000
  s_mov_b32 s7, 0x20000
  s_lshl_b32 s56, s70, 3
  s_lshl_b32 s57, s3, 1
  s_add_u32 s56, s56, s57
  s_mul_i32 s56, s56, 57344
  v_bfe_u32 v3, v1, 4, 1
  v_mul_u32_u24 v3, 57344, v3
  v_lshrrev_b32 v4, 5, v1
  v_lshl_add_u32 v3, v4, 8, v3
  v_and_b32 v4, 15, v1
  v_lshl_add_u32 v3, v4, 4, v3
  v_add_u32 v3, s56, v3
  s_lshl_b32 s72, s71, 11
  s_mul_i32 s73, s71, 1536
  s_add_u32 s73, s73, 32768
  ds_read_b64_tr_b16 v[48:49], v8 offset:0
  ds_read_b64_tr_b16 v[50:51], v8 offset:2048
  ds_read_b64_tr_b16 v[52:53], v8 offset:8192
  ds_read_b64_tr_b16 v[54:55], v8 offset:10240
  ds_read_b64_tr_b16 v[56:57], v9 offset:0
  ds_read_b64_tr_b16 v[58:59], v9 offset:2048
  ds_read_b64_tr_b16 v[60:61], v9 offset:8192
  ds_read_b64_tr_b16 v[62:63], v9 offset:10240
  ds_read_b64_tr_b16 v[64:65], v10 offset:0
  ds_read_b64_tr_b16 v[66:67], v10 offset:2048
  ds_read_b64_tr_b16 v[68:69], v10 offset:8192
  ds_read_b64_tr_b16 v[70:71], v10 offset:10240
  s_waitcnt vmcnt(4)
  s_waitcnt lgkmcnt(8)
  v_mfma_f32_16x16x32_bf16 v[128:131], v[48:51], a[0:3], 0
  ds_read_b64_tr_b16 v[72:73], v11 offset:0
  v_mfma_f32_16x16x32_bf16 v[132:135], v[48:51], a[4:7], 0
  ds_read_b64_tr_b16 v[74:75], v11 offset:2048
  s_mov_b32 s101, 4096
  buffer_load_dwordx4 a[32:35], v16, s[48:51], s101 offen offset:0 sc1
  v_mfma_f32_16x16x32_bf16 v[136:139], v[52:55], a[0:3], 0
  ds_read_b64_tr_b16 v[76:77], v11 offset:8192
  v_mfma_f32_16x16x32_bf16 v[140:143], v[52:55], a[4:7], 0
  ds_read_b64_tr_b16 v[78:79], v11 offset:10240
  s_waitcnt lgkmcnt(8)
  v_mfma_f32_16x16x32_bf16 v[144:147], v[56:59], a[0:3], 0
  ds_read_b64_tr_b16 v[48:49], v8 offset:4096
  v_mfma_f32_16x16x32_bf16 v[148:151], v[56:59], a[4:7], 0
  ds_read_b64_tr_b16 v[50:51], v8 offset:6144
  buffer_load_dwordx4 a[36:39], v19, s[48:51], s101 offen offset:0 sc1
  v_mfma_f32_16x16x32_bf16 v[152:155], v[60:63], a[0:3], 0
  ds_read_b64_tr_b16 v[52:53], v8 offset:12288
  v_mfma_f32_16x16x32_bf16 v[156:159], v[60:63], a[4:7], 0
  ds_read_b64_tr_b16 v[54:55], v8 offset:14336
  s_waitcnt lgkmcnt(8)
  v_mfma_f32_16x16x32_bf16 v[160:163], v[64:67], a[0:3], 0
  ds_read_b64_tr_b16 v[56:57], v9 offset:4096
  v_mfma_f32_16x16x32_bf16 v[164:167], v[64:67], a[4:7], 0
  ds_read_b64_tr_b16 v[58:59], v9 offset:6144
  buffer_load_dwordx4 a[40:43], v16, s[48:51], s101 offen offset:1024 sc1
  v_mfma_f32_16x16x32_bf16 v[168:171], v[68:71], a[0:3], 0
  ds_read_b64_tr_b16 v[60:61], v9 offset:12288
  v_mfma_f32_16x16x32_bf16 v[172:175], v[68:71], a[4:7], 0
  ds_read_b64_tr_b16 v[62:63], v9 offset:14336
  s_waitcnt lgkmcnt(8)
  v_mfma_f32_16x16x32_bf16 v[176:179], v[72:75], a[0:3], 0
  ds_read_b64_tr_b16 v[64:65], v10 offset:4096
  v_mfma_f32_16x16x32_bf16 v[180:183], v[72:75], a[4:7], 0
  ds_read_b64_tr_b16 v[66:67], v10 offset:6144
  buffer_load_dwordx4 a[44:47], v19, s[48:51], s101 offen offset:1024 sc1
  v_mfma_f32_16x16x32_bf16 v[184:187], v[76:79], a[0:3], 0
  ds_read_b64_tr_b16 v[68:69], v10 offset:12288
  v_mfma_f32_16x16x32_bf16 v[188:191], v[76:79], a[4:7], 0
  ds_read_b64_tr_b16 v[70:71], v10 offset:14336
  s_waitcnt lgkmcnt(8)
  v_mfma_f32_16x16x32_bf16 v[128:131], v[48:51], a[8:11], v[128:131]
  ds_read_b64_tr_b16 v[72:73], v11 offset:4096
  v_mfma_f32_16x16x32_bf16 v[132:135], v[48:51], a[12:15], v[132:135]
  ds_read_b64_tr_b16 v[74:75], v11 offset:6144
  s_mov_b32 s101, 6144
  buffer_load_dwordx4 a[48:51], v16, s[48:51], s101 offen offset:0 sc1
  v_mfma_f32_16x16x32_bf16 v[136:139], v[52:55], a[8:11], v[136:139]
  ds_read_b64_tr_b16 v[76:77], v11 offset:12288
  v_mfma_f32_16x16x32_bf16 v[140:143], v[52:55], a[12:15], v[140:143]
  ds_read_b64_tr_b16 v[78:79], v11 offset:14336
  s_waitcnt vmcnt(5)
  s_waitcnt lgkmcnt(8)
  v_mfma_f32_16x16x32_bf16 v[144:147], v[56:59], a[8:11], v[144:147]
  ds_read_b64_tr_b16 v[48:49], v8 offset:16384
  v_mfma_f32_16x16x32_bf16 v[148:151], v[56:59], a[12:15], v[148:151]
  ds_read_b64_tr_b16 v[50:51], v8 offset:18432
  buffer_load_dwordx4 a[52:55], v19, s[48:51], s101 offen offset:0 sc1
  v_mfma_f32_16x16x32_bf16 v[152:155], v[60:63], a[8:11], v[152:155]
  ds_read_b64_tr_b16 v[52:53], v8 offset:24576
  v_mfma_f32_16x16x32_bf16 v[156:159], v[60:63], a[12:15], v[156:159]
  ds_read_b64_tr_b16 v[54:55], v8 offset:26624
  s_waitcnt lgkmcnt(8)
  v_mfma_f32_16x16x32_bf16 v[160:163], v[64:67], a[8:11], v[160:163]
  ds_read_b64_tr_b16 v[56:57], v9 offset:16384
  v_mfma_f32_16x16x32_bf16 v[164:167], v[64:67], a[12:15], v[164:167]
  ds_read_b64_tr_b16 v[58:59], v9 offset:18432
  buffer_load_dwordx4 a[56:59], v16, s[48:51], s101 offen offset:1024 sc1
  v_mfma_f32_16x16x32_bf16 v[168:171], v[68:71], a[8:11], v[168:171]
  ds_read_b64_tr_b16 v[60:61], v9 offset:24576
  v_mfma_f32_16x16x32_bf16 v[172:175], v[68:71], a[12:15], v[172:175]
  ds_read_b64_tr_b16 v[62:63], v9 offset:26624
  s_waitcnt lgkmcnt(8)
  v_mfma_f32_16x16x32_bf16 v[176:179], v[72:75], a[8:11], v[176:179]
  ds_read_b64_tr_b16 v[64:65], v10 offset:16384
  v_mfma_f32_16x16x32_bf16 v[180:183], v[72:75], a[12:15], v[180:183]
  ds_read_b64_tr_b16 v[66:67], v10 offset:18432
  buffer_load_dwordx4 a[60:63], v19, s[48:51], s101 offen offset:1024 sc1
  v_mfma_f32_16x16x32_bf16 v[184:187], v[76:79], a[8:11], v[184:187]
  ds_read_b64_tr_b16 v[68:69], v10 offset:24576
  v_mfma_f32_16x16x32_bf16 v[188:191], v[76:79], a[12:15], v[188:191]
  ds_read_b64_tr_b16 v[70:71], v10 offset:26624
  s_waitcnt lgkmcnt(8)
  v_mfma_f32_16x16x32_bf16 v[128:131], v[48:51], a[16:19], v[128:131]
  ds_read_b64_tr_b16 v[72:73], v11 offset:16384
  v_mfma_f32_16x16x32_bf16 v[132:135], v[48:51], a[20:23], v[132:135]
  ds_read_b64_tr_b16 v[74:75], v11 offset:18432
  s_mov_b32 s101, 8192
  buffer_load_dwordx4 a[64:67], v16, s[48:51], s101 offen offset:0 sc1
  v_mfma_f32_16x16x32_bf16 v[136:139], v[52:55], a[16:19], v[136:139]
  ds_read_b64_tr_b16 v[76:77], v11 offset:24576
  v_mfma_f32_16x16x32_bf16 v[140:143], v[52:55], a[20:23], v[140:143]
  ds_read_b64_tr_b16 v[78:79], v11 offset:26624
  s_waitcnt lgkmcnt(8)
  v_mfma_f32_16x16x32_bf16 v[144:147], v[56:59], a[16:19], v[144:147]
  ds_read_b64_tr_b16 v[48:49], v8 offset:20480
  v_mfma_f32_16x16x32_bf16 v[148:151], v[56:59], a[20:23], v[148:151]
  ds_read_b64_tr_b16 v[50:51], v8 offset:22528
  buffer_load_dwordx4 a[68:71], v19, s[48:51], s101 offen offset:0 sc1
  v_mfma_f32_16x16x32_bf16 v[152:155], v[60:63], a[16:19], v[152:155]
  ds_read_b64_tr_b16 v[52:53], v8 offset:28672
  v_mfma_f32_16x16x32_bf16 v[156:159], v[60:63], a[20:23], v[156:159]
  ds_read_b64_tr_b16 v[54:55], v8 offset:30720
  s_waitcnt lgkmcnt(8)
  v_mfma_f32_16x16x32_bf16 v[160:163], v[64:67], a[16:19], v[160:163]
  ds_read_b64_tr_b16 v[56:57], v9 offset:20480
  v_mfma_f32_16x16x32_bf16 v[164:167], v[64:67], a[20:23], v[164:167]
  ds_read_b64_tr_b16 v[58:59], v9 offset:22528
  buffer_load_dwordx4 a[72:75], v16, s[48:51], s101 offen offset:1024 sc1
  v_mfma_f32_16x16x32_bf16 v[168:171], v[68:71], a[16:19], v[168:171]
  ds_read_b64_tr_b16 v[60:61], v9 offset:28672
  v_mfma_f32_16x16x32_bf16 v[172:175], v[68:71], a[20:23], v[172:175]
  ds_read_b64_tr_b16 v[62:63], v9 offset:30720
  s_waitcnt lgkmcnt(8)
  v_mfma_f32_16x16x32_bf16 v[176:179], v[72:75], a[16:19], v[176:179]
  ds_read_b64_tr_b16 v[64:65], v10 offset:20480
  v_mfma_f32_16x16x32_bf16 v[180:183], v[72:75], a[20:23], v[180:183]
  ds_read_b64_tr_b16 v[66:67], v10 offset:22528
  buffer_load_dwordx4 a[76:79], v19, s[48:51], s101 offen offset:1024 sc1
  v_mfma_f32_16x16x32_bf16 v[184:187], v[76:79], a[16:19], v[184:187]
  ds_read_b64_tr_b16 v[68:69], v10 offset:28672
  v_mfma_f32_16x16x32_bf16 v[188:191], v[76:79], a[20:23], v[188:191]
  ds_read_b64_tr_b16 v[70:71], v10 offset:30720
  s_waitcnt lgkmcnt(8)
  v_mfma_f32_16x16x32_bf16 v[128:131], v[48:51], a[24:27], v[128:131]
  ds_read_b64_tr_b16 v[72:73], v11 offset:20480
  v_mfma_f32_16x16x32_bf16 v[132:135], v[48:51], a[28:31], v[132:135]
  ds_read_b64_tr_b16 v[74:75], v11 offset:22528
  v_mfma_f32_16x16x32_bf16 v[136:139], v[52:55], a[24:27], v[136:139]
  ds_read_b64_tr_b16 v[76:77], v11 offset:28672
  v_mfma_f32_16x16x32_bf16 v[140:143], v[52:55], a[28:31], v[140:143]
  ds_read_b64_tr_b16 v[78:79], v11 offset:30720
  s_waitcnt vmcnt(8)
  s_barrier
  s_waitcnt lgkmcnt(8)
  v_mfma_f32_16x16x32_bf16 v[144:147], v[56:59], a[24:27], v[144:147]
  ds_read_b64_tr_b16 v[48:49], v8 offset:32768
  v_mfma_f32_16x16x32_bf16 v[148:151], v[56:59], a[28:31], v[148:151]
  ds_read_b64_tr_b16 v[50:51], v8 offset:34816
  s_mov_b32 s101, 10240
  buffer_load_dwordx4 a[80:83], v16, s[48:51], s101 offen offset:0 sc1
  v_mfma_f32_16x16x32_bf16 v[152:155], v[60:63], a[24:27], v[152:155]
  ds_read_b64_tr_b16 v[52:53], v8 offset:40960
  v_mfma_f32_16x16x32_bf16 v[156:159], v[60:63], a[28:31], v[156:159]
  ds_read_b64_tr_b16 v[54:55], v8 offset:43008
  s_waitcnt lgkmcnt(8)
  v_mfma_f32_16x16x32_bf16 v[160:163], v[64:67], a[24:27], v[160:163]
  ds_read_b64_tr_b16 v[56:57], v9 offset:32768
  v_mfma_f32_16x16x32_bf16 v[164:167], v[64:67], a[28:31], v[164:167]
  ds_read_b64_tr_b16 v[58:59], v9 offset:34816
  buffer_load_dwordx4 a[84:87], v19, s[48:51], s101 offen offset:0 sc1
  v_mfma_f32_16x16x32_bf16 v[168:171], v[68:71], a[24:27], v[168:171]
  ds_read_b64_tr_b16 v[60:61], v9 offset:40960
  v_mfma_f32_16x16x32_bf16 v[172:175], v[68:71], a[28:31], v[172:175]
  ds_read_b64_tr_b16 v[62:63], v9 offset:43008
  s_waitcnt lgkmcnt(8)
  v_mfma_f32_16x16x32_bf16 v[176:179], v[72:75], a[24:27], v[176:179]
  ds_read_b64_tr_b16 v[64:65], v10 offset:32768
  v_mfma_f32_16x16x32_bf16 v[180:183], v[72:75], a[28:31], v[180:183]
  ds_read_b64_tr_b16 v[66:67], v10 offset:34816
  buffer_load_dwordx4 a[88:91], v16, s[48:51], s101 offen offset:1024 sc1
  v_mfma_f32_16x16x32_bf16 v[184:187], v[76:79], a[24:27], v[184:187]
  ds_read_b64_tr_b16 v[68:69], v10 offset:40960
  v_mfma_f32_16x16x32_bf16 v[188:191], v[76:79], a[28:31], v[188:191]
  ds_read_b64_tr_b16 v[70:71], v10 offset:43008
  s_waitcnt lgkmcnt(8)
  v_mfma_f32_16x16x32_bf16 v[128:131], v[48:51], a[32:35], v[128:131]
  ds_read_b64_tr_b16 v[72:73], v11 offset:32768
  v_mfma_f32_16x16x32_bf16 v[132:135], v[48:51], a[36:39], v[132:135]
  ds_read_b64_tr_b16 v[74:75], v11 offset:34816
  buffer_load_dwordx4 a[92:95], v19, s[48:51], s101 offen offset:1024 sc1
  v_mfma_f32_16x16x32_bf16 v[136:139], v[52:55], a[32:35], v[136:139]
  ds_read_b64_tr_b16 v[76:77], v11 offset:40960
  v_mfma_f32_16x16x32_bf16 v[140:143], v[52:55], a[36:39], v[140:143]
  ds_read_b64_tr_b16 v[78:79], v11 offset:43008
  s_waitcnt lgkmcnt(8)
  v_mfma_f32_16x16x32_bf16 v[144:147], v[56:59], a[32:35], v[144:147]
  ds_read_b64_tr_b16 v[48:49], v8 offset:36864
  v_mfma_f32_16x16x32_bf16 v[148:151], v[56:59], a[36:39], v[148:151]
  ds_read_b64_tr_b16 v[50:51], v8 offset:38912
  s_mov_b32 s100, 0
  s_add_u32 m0, s86, 0
  s_nop 0
  buffer_load_dwordx4 v12, s[88:91], s100 offen offset:0 lds
  v_mfma_f32_16x16x32_bf16 v[152:155], v[60:63], a[32:35], v[152:155]
  ds_read_b64_tr_b16 v[52:53], v8 offset:45056
  v_mfma_f32_16x16x32_bf16 v[156:159], v[60:63], a[36:39], v[156:159]
  ds_read_b64_tr_b16 v[54:55], v8 offset:47104
  s_waitcnt lgkmcnt(8)
  v_mfma_f32_16x16x32_bf16 v[160:163], v[64:67], a[32:35], v[160:163]
  ds_read_b64_tr_b16 v[56:57], v9 offset:36864
  v_mfma_f32_16x16x32_bf16 v[164:167], v[64:67], a[36:39], v[164:167]
  ds_read_b64_tr_b16 v[58:59], v9 offset:38912
  buffer_load_dwordx4 v13, s[88:91], s100 offen offset:1024 lds
  v_mfma_f32_16x16x32_bf16 v[168:171], v[68:71], a[32:35], v[168:171]
  ds_read_b64_tr_b16 v[60:61], v9 offset:45056
  v_mfma_f32_16x16x32_bf16 v[172:175], v[68:71], a[36:39], v[172:175]
  ds_read_b64_tr_b16 v[62:63], v9 offset:47104
  s_waitcnt lgkmcnt(8)
  v_mfma_f32_16x16x32_bf16 v[176:179], v[72:75], a[32:35], v[176:179]
  ds_read_b64_tr_b16 v[64:65], v10 offset:36864
  v_mfma_f32_16x16x32_bf16 v[180:183], v[72:75], a[36:39], v[180:183]
  ds_read_b64_tr_b16 v[66:67], v10 offset:38912
  buffer_load_dwordx4 v17, s[88:91], s100 offen offset:2048 lds
  v_mfma_f32_16x16x32_bf16 v[184:187], v[76:79], a[32:35], v[184:187]
  ds_read_b64_tr_b16 v[68:69], v10 offset:45056
  v_mfma_f32_16x16x32_bf16 v[188:191], v[76:79], a[36:39], v[188:191]
  ds_read_b64_tr_b16 v[70:71], v10 offset:47104
  s_waitcnt lgkmcnt(8)
  v_mfma_f32_16x16x32_bf16 v[128:131], v[48:51], a[40:43], v[128:131]
  ds_read_b64_tr_b16 v[72:73], v11 offset:36864
  v_mfma_f32_16x16x32_bf16 v[132:135], v[48:51], a[44:47], v[132:135]
  ds_read_b64_tr_b16 v[74:75], v11 offset:38912
  buffer_load_dwordx4 v18, s[88:91], s100 offen offset:3072 lds
  v_mfma_f32_16x16x32_bf16 v[136:139], v[52:55], a[40:43], v[136:139]
  ds_read_b64_tr_b16 v[76:77], v11 offset:45056
  v_mfma_f32_16x16x32_bf16 v[140:143], v[52:55], a[44:47], v[140:143]
  ds_read_b64_tr_b16 v[78:79], v11 offset:47104
  s_waitcnt vmcnt(12)
  s_waitcnt lgkmcnt(8)
  v_mfma_f32_16x16x32_bf16 v[144:147], v[56:59], a[40:43], v[144:147]
  ds_read_b64_tr_b16 v[48:49], v8 offset:49152
  v_mfma_f32_16x16x32_bf16 v[148:151], v[56:59], a[44:47], v[148:151]
  ds_read_b64_tr_b16 v[50:51], v8 offset:51200
  s_mov_b32 s101, 12288
  buffer_load_dwordx4 a[96:99], v16, s[48:51], s101 offen offset:0 sc1
  v_mfma_f32_16x16x32_bf16 v[152:155], v[60:63], a[40:43], v[152:155]
  ds_read_b64_tr_b16 v[52:53], v8 offset:57344
  v_mfma_f32_16x16x32_bf16 v[156:159], v[60:63], a[44:47], v[156:159]
  ds_read_b64_tr_b16 v[54:55], v8 offset:59392
  s_waitcnt lgkmcnt(8)
  v_mfma_f32_16x16x32_bf16 v[160:163], v[64:67], a[40:43], v[160:163]
  ds_read_b64_tr_b16 v[56:57], v9 offset:49152
  v_mfma_f32_16x16x32_bf16 v[164:167], v[64:67], a[44:47], v[164:167]
  ds_read_b64_tr_b16 v[58:59], v9 offset:51200
  buffer_load_dwordx4 a[100:103], v19, s[48:51], s101 offen offset:0 sc1
  v_mfma_f32_16x16x32_bf16 v[168:171], v[68:71], a[40:43], v[168:171]
  ds_read_b64_tr_b16 v[60:61], v9 offset:57344
  v_mfma_f32_16x16x32_bf16 v[172:175], v[68:71], a[44:47], v[172:175]
  ds_read_b64_tr_b16 v[62:63], v9 offset:59392
  s_waitcnt lgkmcnt(8)
  v_mfma_f32_16x16x32_bf16 v[176:179], v[72:75], a[40:43], v[176:179]
  ds_read_b64_tr_b16 v[64:65], v10 offset:49152
  v_mfma_f32_16x16x32_bf16 v[180:183], v[72:75], a[44:47], v[180:183]
  ds_read_b64_tr_b16 v[66:67], v10 offset:51200
  buffer_load_dwordx4 a[104:107], v16, s[48:51], s101 offen offset:1024 sc1
  v_mfma_f32_16x16x32_bf16 v[184:187], v[76:79], a[40:43], v[184:187]
  ds_read_b64_tr_b16 v[68:69], v10 offset:57344
  v_mfma_f32_16x16x32_bf16 v[188:191], v[76:79], a[44:47], v[188:191]
  ds_read_b64_tr_b16 v[70:71], v10 offset:59392
  s_waitcnt lgkmcnt(8)
  v_mfma_f32_16x16x32_bf16 v[128:131], v[48:51], a[48:51], v[128:131]
  ds_read_b64_tr_b16 v[72:73], v11 offset:49152
  v_mfma_f32_16x16x32_bf16 v[132:135], v[48:51], a[52:55], v[132:135]
  ds_read_b64_tr_b16 v[74:75], v11 offset:51200
  buffer_load_dwordx4 a[108:111], v19, s[48:51], s101 offen offset:1024 sc1
  v_mfma_f32_16x16x32_bf16 v[136:139], v[52:55], a[48:51], v[136:139]
  ds_read_b64_tr_b16 v[76:77], v11 offset:57344
  v_mfma_f32_16x16x32_bf16 v[140:143], v[52:55], a[52:55], v[140:143]
  ds_read_b64_tr_b16 v[78:79], v11 offset:59392
  s_waitcnt lgkmcnt(8)
  v_mfma_f32_16x16x32_bf16 v[144:147], v[56:59], a[48:51], v[144:147]
  ds_read_b64_tr_b16 v[48:49], v8 offset:53248
  v_mfma_f32_16x16x32_bf16 v[148:151], v[56:59], a[52:55], v[148:151]
  ds_read_b64_tr_b16 v[50:51], v8 offset:55296
  v_mfma_f32_16x16x32_bf16 v[152:155], v[60:63], a[48:51], v[152:155]
  ds_read_b64_tr_b16 v[52:53], v8 offset:61440
  v_mfma_f32_16x16x32_bf16 v[156:159], v[60:63], a[52:55], v[156:159]
  ds_read_b64_tr_b16 v[54:55], v8 offset:63488
  s_waitcnt lgkmcnt(8)
  v_mfma_f32_16x16x32_bf16 v[160:163], v[64:67], a[48:51], v[160:163]
  ds_read_b64_tr_b16 v[56:57], v9 offset:53248
  v_mfma_f32_16x16x32_bf16 v[164:167], v[64:67], a[52:55], v[164:167]
  ds_read_b64_tr_b16 v[58:59], v9 offset:55296
  v_mfma_f32_16x16x32_bf16 v[168:171], v[68:71], a[48:51], v[168:171]
  ds_read_b64_tr_b16 v[60:61], v9 offset:61440
  v_mfma_f32_16x16x32_bf16 v[172:175], v[68:71], a[52:55], v[172:175]
  ds_read_b64_tr_b16 v[62:63], v9 offset:63488
  s_waitcnt lgkmcnt(8)
  v_mfma_f32_16x16x32_bf16 v[176:179], v[72:75], a[48:51], v[176:179]
  ds_read_b64_tr_b16 v[64:65], v10 offset:53248
  v_mfma_f32_16x16x32_bf16 v[180:183], v[72:75], a[52:55], v[180:183]
  ds_read_b64_tr_b16 v[66:67], v10 offset:55296
  v_mfma_f32_16x16x32_bf16 v[184:187], v[76:79], a[48:51], v[184:187]
  ds_read_b64_tr_b16 v[68:69], v10 offset:61440
  v_mfma_f32_16x16x32_bf16 v[188:191], v[76:79], a[52:55], v[188:191]
  ds_read_b64_tr_b16 v[70:71], v10 offset:63488
  s_waitcnt lgkmcnt(8)
  v_mfma_f32_16x16x32_bf16 v[128:131], v[48:51], a[56:59], v[128:131]
  ds_read_b64_tr_b16 v[72:73], v11 offset:53248
  v_mfma_f32_16x16x32_bf16 v[132:135], v[48:51], a[60:63], v[132:135]
  ds_read_b64_tr_b16 v[74:75], v11 offset:55296
  v_mfma_f32_16x16x32_bf16 v[136:139], v[52:55], a[56:59], v[136:139]
  ds_read_b64_tr_b16 v[76:77], v11 offset:61440
  v_mfma_f32_16x16x32_bf16 v[140:143], v[52:55], a[60:63], v[140:143]
  ds_read_b64_tr_b16 v[78:79], v11 offset:63488
  v_add_u32 v8, 0x10000, v8
  v_add_u32 v9, 0x10000, v9
  v_add_u32 v10, 0x10000, v10
  v_add_u32 v11, 0x10000, v11
  s_waitcnt vmcnt(12)
  s_barrier
  s_waitcnt lgkmcnt(8)
  v_mfma_f32_16x16x32_bf16 v[144:147], v[56:59], a[56:59], v[144:147]
  ds_read_b64_tr_b16 v[48:49], v8 offset:0
  v_mfma_f32_16x16x32_bf16 v[148:151], v[56:59], a[60:63], v[148:151]
  ds_read_b64_tr_b16 v[50:51], v8 offset:2048
  s_mov_b32 s101, 14336
  buffer_load_dwordx4 a[112:115], v16, s[48:51], s101 offen offset:0 sc1
  v_mfma_f32_16x16x32_bf16 v[152:155], v[60:63], a[56:59], v[152:155]
  ds_read_b64_tr_b16 v[52:53], v8 offset:8192
  v_mfma_f32_16x16x32_bf16 v[156:159], v[60:63], a[60:63], v[156:159]
  ds_read_b64_tr_b16 v[54:55], v8 offset:10240
  s_waitcnt lgkmcnt(8)
  v_mfma_f32_16x16x32_bf16 v[160:163], v[64:67], a[56:59], v[160:163]
  ds_read_b64_tr_b16 v[56:57], v9 offset:0
  v_mfma_f32_16x16x32_bf16 v[164:167], v[64:67], a[60:63], v[164:167]
  ds_read_b64_tr_b16 v[58:59], v9 offset:2048
  buffer_load_dwordx4 a[116:119], v19, s[48:51], s101 offen offset:0 sc1
  v_mfma_f32_16x16x32_bf16 v[168:171], v[68:71], a[56:59], v[168:171]
  ds_read_b64_tr_b16 v[60:61], v9 offset:8192
  v_mfma_f32_16x16x32_bf16 v[172:175], v[68:71], a[60:63], v[172:175]
  ds_read_b64_tr_b16 v[62:63], v9 offset:10240
  s_waitcnt lgkmcnt(8)
  v_mfma_f32_16x16x32_bf16 v[176:179], v[72:75], a[56:59], v[176:179]
  ds_read_b64_tr_b16 v[64:65], v10 offset:0
  v_mfma_f32_16x16x32_bf16 v[180:183], v[72:75], a[60:63], v[180:183]
  ds_read_b64_tr_b16 v[66:67], v10 offset:2048
  buffer_load_dwordx4 a[120:123], v16, s[48:51], s101 offen offset:1024 sc1
  v_mfma_f32_16x16x32_bf16 v[184:187], v[76:79], a[56:59], v[184:187]
  ds_read_b64_tr_b16 v[68:69], v10 offset:8192
  v_mfma_f32_16x16x32_bf16 v[188:191], v[76:79], a[60:63], v[188:191]
  ds_read_b64_tr_b16 v[70:71], v10 offset:10240
  s_waitcnt lgkmcnt(8)
  v_mfma_f32_16x16x32_bf16 v[128:131], v[48:51], a[64:67], v[128:131]
  ds_read_b64_tr_b16 v[72:73], v11 offset:0
  v_mfma_f32_16x16x32_bf16 v[132:135], v[48:51], a[68:71], v[132:135]
  ds_read_b64_tr_b16 v[74:75], v11 offset:2048
  buffer_load_dwordx4 a[124:127], v19, s[48:51], s101 offen offset:1024 sc1
  v_mfma_f32_16x16x32_bf16 v[136:139], v[52:55], a[64:67], v[136:139]
  ds_read_b64_tr_b16 v[76:77], v11 offset:8192
  v_mfma_f32_16x16x32_bf16 v[140:143], v[52:55], a[68:71], v[140:143]
  ds_read_b64_tr_b16 v[78:79], v11 offset:10240
  s_waitcnt lgkmcnt(8)
  v_mfma_f32_16x16x32_bf16 v[144:147], v[56:59], a[64:67], v[144:147]
  ds_read_b64_tr_b16 v[48:49], v8 offset:4096
  v_mfma_f32_16x16x32_bf16 v[148:151], v[56:59], a[68:71], v[148:151]
  ds_read_b64_tr_b16 v[50:51], v8 offset:6144
  s_mov_b32 s100, 229376
  s_add_u32 m0, s86, 16384
  s_nop 0
  buffer_load_dwordx4 v12, s[88:91], s100 offen offset:0 lds
  v_mfma_f32_16x16x32_bf16 v[152:155], v[60:63], a[64:67], v[152:155]
  ds_read_b64_tr_b16 v[52:53], v8 offset:12288
  v_mfma_f32_16x16x32_bf16 v[156:159], v[60:63], a[68:71], v[156:159]
  ds_read_b64_tr_b16 v[54:55], v8 offset:14336
  s_waitcnt lgkmcnt(8)
  v_mfma_f32_16x16x32_bf16 v[160:163], v[64:67], a[64:67], v[160:163]
  ds_read_b64_tr_b16 v[56:57], v9 offset:4096
  v_mfma_f32_16x16x32_bf16 v[164:167], v[64:67], a[68:71], v[164:167]
  ds_read_b64_tr_b16 v[58:59], v9 offset:6144
  buffer_load_dwordx4 v13, s[88:91], s100 offen offset:1024 lds
  v_mfma_f32_16x16x32_bf16 v[168:171], v[68:71], a[64:67], v[168:171]
  ds_read_b64_tr_b16 v[60:61], v9 offset:12288
  v_mfma_f32_16x16x32_bf16 v[172:175], v[68:71], a[68:71], v[172:175]
  ds_read_b64_tr_b16 v[62:63], v9 offset:14336
  s_waitcnt lgkmcnt(8)
  v_mfma_f32_16x16x32_bf16 v[176:179], v[72:75], a[64:67], v[176:179]
  ds_read_b64_tr_b16 v[64:65], v10 offset:4096
  v_mfma_f32_16x16x32_bf16 v[180:183], v[72:75], a[68:71], v[180:183]
  ds_read_b64_tr_b16 v[66:67], v10 offset:6144
  buffer_load_dwordx4 v17, s[88:91], s100 offen offset:2048 lds
  v_mfma_f32_16x16x32_bf16 v[184:187], v[76:79], a[64:67], v[184:187]
  ds_read_b64_tr_b16 v[68:69], v10 offset:12288
  v_mfma_f32_16x16x32_bf16 v[188:191], v[76:79], a[68:71], v[188:191]
  ds_read_b64_tr_b16 v[70:71], v10 offset:14336
  s_waitcnt lgkmcnt(8)
  v_mfma_f32_16x16x32_bf16 v[128:131], v[48:51], a[72:75], v[128:131]
  ds_read_b64_tr_b16 v[72:73], v11 offset:4096
  v_mfma_f32_16x16x32_bf16 v[132:135], v[48:51], a[76:79], v[132:135]
  ds_read_b64_tr_b16 v[74:75], v11 offset:6144
  buffer_load_dwordx4 v18, s[88:91], s100 offen offset:3072 lds
  v_mfma_f32_16x16x32_bf16 v[136:139], v[52:55], a[72:75], v[136:139]
  ds_read_b64_tr_b16 v[76:77], v11 offset:12288
  v_mfma_f32_16x16x32_bf16 v[140:143], v[52:55], a[76:79], v[140:143]
  ds_read_b64_tr_b16 v[78:79], v11 offset:14336
  s_waitcnt vmcnt(16)
  s_waitcnt lgkmcnt(8)
  v_mfma_f32_16x16x32_bf16 v[144:147], v[56:59], a[72:75], v[144:147]
  ds_read_b64_tr_b16 v[48:49], v8 offset:16384
  v_mfma_f32_16x16x32_bf16 v[148:151], v[56:59], a[76:79], v[148:151]
  ds_read_b64_tr_b16 v[50:51], v8 offset:18432
  s_mov_b32 s100, 458752
  s_add_u32 m0, s86, 32768
  s_nop 0
  buffer_load_dwordx4 v12, s[88:91], s100 offen offset:0 lds
  v_mfma_f32_16x16x32_bf16 v[152:155], v[60:63], a[72:75], v[152:155]
  ds_read_b64_tr_b16 v[52:53], v8 offset:24576
  v_mfma_f32_16x16x32_bf16 v[156:159], v[60:63], a[76:79], v[156:159]
  ds_read_b64_tr_b16 v[54:55], v8 offset:26624
  s_waitcnt lgkmcnt(8)
  v_mfma_f32_16x16x32_bf16 v[160:163], v[64:67], a[72:75], v[160:163]
  ds_read_b64_tr_b16 v[56:57], v9 offset:16384
  v_mfma_f32_16x16x32_bf16 v[164:167], v[64:67], a[76:79], v[164:167]
  ds_read_b64_tr_b16 v[58:59], v9 offset:18432
  buffer_load_dwordx4 v13, s[88:91], s100 offen offset:1024 lds
  v_mfma_f32_16x16x32_bf16 v[168:171], v[68:71], a[72:75], v[168:171]
  ds_read_b64_tr_b16 v[60:61], v9 offset:24576
  v_mfma_f32_16x16x32_bf16 v[172:175], v[68:71], a[76:79], v[172:175]
  ds_read_b64_tr_b16 v[62:63], v9 offset:26624
  s_waitcnt lgkmcnt(8)
  v_mfma_f32_16x16x32_bf16 v[176:179], v[72:75], a[72:75], v[176:179]
  ds_read_b64_tr_b16 v[64:65], v10 offset:16384
  v_mfma_f32_16x16x32_bf16 v[180:183], v[72:75], a[76:79], v[180:183]
  ds_read_b64_tr_b16 v[66:67], v10 offset:18432
  buffer_load_dwordx4 v17, s[88:91], s100 offen offset:2048 lds
  v_mfma_f32_16x16x32_bf16 v[184:187], v[76:79], a[72:75], v[184:187]
  ds_read_b64_tr_b16 v[68:69], v10 offset:24576
  v_mfma_f32_16x16x32_bf16 v[188:191], v[76:79], a[76:79], v[188:191]
  ds_read_b64_tr_b16 v[70:71], v10 offset:26624
  s_waitcnt lgkmcnt(8)
  v_mfma_f32_16x16x32_bf16 v[128:131], v[48:51], a[80:83], v[128:131]
  ds_read_b64_tr_b16 v[72:73], v11 offset:16384
  v_mfma_f32_16x16x32_bf16 v[132:135], v[48:51], a[84:87], v[132:135]
  ds_read_b64_tr_b16 v[74:75], v11 offset:18432
  buffer_load_dwordx4 v18, s[88:91], s100 offen offset:3072 lds
  v_mfma_f32_16x16x32_bf16 v[136:139], v[52:55], a[80:83], v[136:139]
  ds_read_b64_tr_b16 v[76:77], v11 offset:24576
  v_mfma_f32_16x16x32_bf16 v[140:143], v[52:55], a[84:87], v[140:143]
  ds_read_b64_tr_b16 v[78:79], v11 offset:26624
  s_waitcnt lgkmcnt(8)
  v_mfma_f32_16x16x32_bf16 v[144:147], v[56:59], a[80:83], v[144:147]
  ds_read_b64_tr_b16 v[48:49], v8 offset:20480
  v_mfma_f32_16x16x32_bf16 v[148:151], v[56:59], a[84:87], v[148:151]
  ds_read_b64_tr_b16 v[50:51], v8 offset:22528
  v_mfma_f32_16x16x32_bf16 v[152:155], v[60:63], a[80:83], v[152:155]
  ds_read_b64_tr_b16 v[52:53], v8 offset:28672
  v_mfma_f32_16x16x32_bf16 v[156:159], v[60:63], a[84:87], v[156:159]
  ds_read_b64_tr_b16 v[54:55], v8 offset:30720
  s_waitcnt lgkmcnt(8)
  v_mfma_f32_16x16x32_bf16 v[160:163], v[64:67], a[80:83], v[160:163]
  ds_read_b64_tr_b16 v[56:57], v9 offset:20480
  v_mfma_f32_16x16x32_bf16 v[164:167], v[64:67], a[84:87], v[164:167]
  ds_read_b64_tr_b16 v[58:59], v9 offset:22528
  v_mfma_f32_16x16x32_bf16 v[168:171], v[68:71], a[80:83], v[168:171]
  ds_read_b64_tr_b16 v[60:61], v9 offset:28672
  v_mfma_f32_16x16x32_bf16 v[172:175], v[68:71], a[84:87], v[172:175]
  ds_read_b64_tr_b16 v[62:63], v9 offset:30720
  s_waitcnt lgkmcnt(8)
  v_mfma_f32_16x16x32_bf16 v[176:179], v[72:75], a[80:83], v[176:179]
  ds_read_b64_tr_b16 v[64:65], v10 offset:20480
  v_mfma_f32_16x16x32_bf16 v[180:183], v[72:75], a[84:87], v[180:183]
  ds_read_b64_tr_b16 v[66:67], v10 offset:22528
  v_mfma_f32_16x16x32_bf16 v[184:187], v[76:79], a[80:83], v[184:187]
  ds_read_b64_tr_b16 v[68:69], v10 offset:28672
  v_mfma_f32_16x16x32_bf16 v[188:191], v[76:79], a[84:87], v[188:191]
  ds_read_b64_tr_b16 v[70:71], v10 offset:30720
  s_waitcnt lgkmcnt(8)
  v_mfma_f32_16x16x32_bf16 v[128:131], v[48:51], a[88:91], v[128:131]
  ds_read_b64_tr_b16 v[72:73], v11 offset:20480
  v_mfma_f32_16x16x32_bf16 v[132:135], v[48:51], a[92:95], v[132:135]
  ds_read_b64_tr_b16 v[74:75], v11 offset:22528
  v_mfma_f32_16x16x32_bf16 v[136:139], v[52:55], a[88:91], v[136:139]
  ds_read_b64_tr_b16 v[76:77], v11 offset:28672
  v_mfma_f32_16x16x32_bf16 v[140:143], v[52:55], a[92:95], v[140:143]
  ds_read_b64_tr_b16 v[78:79], v11 offset:30720
  s_waitcnt vmcnt(12)
  s_barrier
  s_waitcnt lgkmcnt(8)
  v_mfma_f32_16x16x32_bf16 v[144:147], v[56:59], a[88:91], v[144:147]
  ds_read_b64_tr_b16 v[48:49], v8 offset:32768
  v_mfma_f32_16x16x32_bf16 v[148:151], v[56:59], a[92:95], v[148:151]
  ds_read_b64_tr_b16 v[50:51], v8 offset:34816
  s_mov_b32 s100, 688128
  s_add_u32 m0, s86, 49152
  s_nop 0
  buffer_load_dwordx4 v12, s[88:91], s100 offen offset:0 lds
  v_mfma_f32_16x16x32_bf16 v[152:155], v[60:63], a[88:91], v[152:155]
  ds_read_b64_tr_b16 v[52:53], v8 offset:40960
  v_mfma_f32_16x16x32_bf16 v[156:159], v[60:63], a[92:95], v[156:159]
  ds_read_b64_tr_b16 v[54:55], v8 offset:43008
  s_waitcnt lgkmcnt(8)
  v_mfma_f32_16x16x32_bf16 v[160:163], v[64:67], a[88:91], v[160:163]
  ds_read_b64_tr_b16 v[56:57], v9 offset:32768
  v_mfma_f32_16x16x32_bf16 v[164:167], v[64:67], a[92:95], v[164:167]
  ds_read_b64_tr_b16 v[58:59], v9 offset:34816
  buffer_load_dwordx4 v13, s[88:91], s100 offen offset:1024 lds
  v_mfma_f32_16x16x32_bf16 v[168:171], v[68:71], a[88:91], v[168:171]
  ds_read_b64_tr_b16 v[60:61], v9 offset:40960
  v_mfma_f32_16x16x32_bf16 v[172:175], v[68:71], a[92:95], v[172:175]
  ds_read_b64_tr_b16 v[62:63], v9 offset:43008
  s_waitcnt lgkmcnt(8)
  v_mfma_f32_16x16x32_bf16 v[176:179], v[72:75], a[88:91], v[176:179]
  ds_read_b64_tr_b16 v[64:65], v10 offset:32768
  v_mfma_f32_16x16x32_bf16 v[180:183], v[72:75], a[92:95], v[180:183]
  ds_read_b64_tr_b16 v[66:67], v10 offset:34816
  buffer_load_dwordx4 v17, s[88:91], s100 offen offset:2048 lds
  v_mfma_f32_16x16x32_bf16 v[184:187], v[76:79], a[88:91], v[184:187]
  ds_read_b64_tr_b16 v[68:69], v10 offset:40960
  v_mfma_f32_16x16x32_bf16 v[188:191], v[76:79], a[92:95], v[188:191]
  ds_read_b64_tr_b16 v[70:71], v10 offset:43008
  s_waitcnt lgkmcnt(8)
  v_mfma_f32_16x16x32_bf16 v[128:131], v[48:51], a[96:99], v[128:131]
  ds_read_b64_tr_b16 v[72:73], v11 offset:32768
  v_mfma_f32_16x16x32_bf16 v[132:135], v[48:51], a[100:103], v[132:135]
  ds_read_b64_tr_b16 v[74:75], v11 offset:34816
  buffer_load_dwordx4 v18, s[88:91], s100 offen offset:3072 lds
  v_mfma_f32_16x16x32_bf16 v[136:139], v[52:55], a[96:99], v[136:139]
  ds_read_b64_tr_b16 v[76:77], v11 offset:40960
  v_mfma_f32_16x16x32_bf16 v[140:143], v[52:55], a[100:103], v[140:143]
  ds_read_b64_tr_b16 v[78:79], v11 offset:43008
  s_waitcnt lgkmcnt(8)
  v_mfma_f32_16x16x32_bf16 v[144:147], v[56:59], a[96:99], v[144:147]
  ds_read_b64_tr_b16 v[48:49], v8 offset:36864
  v_mfma_f32_16x16x32_bf16 v[148:151], v[56:59], a[100:103], v[148:151]
  ds_read_b64_tr_b16 v[50:51], v8 offset:38912
  s_mov_b32 s100, 917504
  s_add_u32 m0, s86, 65536
  s_nop 0
  buffer_load_dwordx4 v12, s[88:91], s100 offen offset:0 lds
  v_mfma_f32_16x16x32_bf16 v[152:155], v[60:63], a[96:99], v[152:155]
  ds_read_b64_tr_b16 v[52:53], v8 offset:45056
  v_mfma_f32_16x16x32_bf16 v[156:159], v[60:63], a[100:103], v[156:159]
  ds_read_b64_tr_b16 v[54:55], v8 offset:47104
  s_waitcnt lgkmcnt(8)
  v_mfma_f32_16x16x32_bf16 v[160:163], v[64:67], a[96:99], v[160:163]
  ds_read_b64_tr_b16 v[56:57], v9 offset:36864
  v_mfma_f32_16x16x32_bf16 v[164:167], v[64:67], a[100:103], v[164:167]
  ds_read_b64_tr_b16 v[58:59], v9 offset:38912
  buffer_load_dwordx4 v13, s[88:91], s100 offen offset:1024 lds
  v_mfma_f32_16x16x32_bf16 v[168:171], v[68:71], a[96:99], v[168:171]
  ds_read_b64_tr_b16 v[60:61], v9 offset:45056
  v_mfma_f32_16x16x32_bf16 v[172:175], v[68:71], a[100:103], v[172:175]
  ds_read_b64_tr_b16 v[62:63], v9 offset:47104
  s_waitcnt lgkmcnt(8)
  v_mfma_f32_16x16x32_bf16 v[176:179], v[72:75], a[96:99], v[176:179]
  ds_read_b64_tr_b16 v[64:65], v10 offset:36864
  v_mfma_f32_16x16x32_bf16 v[180:183], v[72:75], a[100:103], v[180:183]
  ds_read_b64_tr_b16 v[66:67], v10 offset:38912
  buffer_load_dwordx4 v17, s[88:91], s100 offen offset:2048 lds
  v_mfma_f32_16x16x32_bf16 v[184:187], v[76:79], a[96:99], v[184:187]
  ds_read_b64_tr_b16 v[68:69], v10 offset:45056
  v_mfma_f32_16x16x32_bf16 v[188:191], v[76:79], a[100:103], v[188:191]
  ds_read_b64_tr_b16 v[70:71], v10 offset:47104
  s_waitcnt lgkmcnt(8)
  v_mfma_f32_16x16x32_bf16 v[128:131], v[48:51], a[104:107], v[128:131]
  ds_read_b64_tr_b16 v[72:73], v11 offset:36864
  v_mfma_f32_16x16x32_bf16 v[132:135], v[48:51], a[108:111], v[132:135]
  ds_read_b64_tr_b16 v[74:75], v11 offset:38912
  buffer_load_dwordx4 v18, s[88:91], s100 offen offset:3072 lds
  v_mfma_f32_16x16x32_bf16 v[136:139], v[52:55], a[104:107], v[136:139]
  ds_read_b64_tr_b16 v[76:77], v11 offset:45056
  v_mfma_f32_16x16x32_bf16 v[140:143], v[52:55], a[108:111], v[140:143]
  ds_read_b64_tr_b16 v[78:79], v11 offset:47104
  s_waitcnt vmcnt(16)
  s_waitcnt lgkmcnt(8)
  v_mfma_f32_16x16x32_bf16 v[144:147], v[56:59], a[104:107], v[144:147]
  ds_read_b64_tr_b16 v[48:49], v8 offset:49152
  v_mfma_f32_16x16x32_bf16 v[148:151], v[56:59], a[108:111], v[148:151]
  ds_read_b64_tr_b16 v[50:51], v8 offset:51200
  v_mfma_f32_16x16x32_bf16 v[152:155], v[60:63], a[104:107], v[152:155]
  ds_read_b64_tr_b16 v[52:53], v8 offset:57344
  v_mfma_f32_16x16x32_bf16 v[156:159], v[60:63], a[108:111], v[156:159]
  ds_read_b64_tr_b16 v[54:55], v8 offset:59392
  s_waitcnt lgkmcnt(8)
  v_mfma_f32_16x16x32_bf16 v[160:163], v[64:67], a[104:107], v[160:163]
  ds_read_b64_tr_b16 v[56:57], v9 offset:49152
  v_mfma_f32_16x16x32_bf16 v[164:167], v[64:67], a[108:111], v[164:167]
  ds_read_b64_tr_b16 v[58:59], v9 offset:51200
  v_mfma_f32_16x16x32_bf16 v[168:171], v[68:71], a[104:107], v[168:171]
  ds_read_b64_tr_b16 v[60:61], v9 offset:57344
  v_mfma_f32_16x16x32_bf16 v[172:175], v[68:71], a[108:111], v[172:175]
  ds_read_b64_tr_b16 v[62:63], v9 offset:59392
  s_waitcnt lgkmcnt(8)
  v_mfma_f32_16x16x32_bf16 v[176:179], v[72:75], a[104:107], v[176:179]
  ds_read_b64_tr_b16 v[64:65], v10 offset:49152
  v_mfma_f32_16x16x32_bf16 v[180:183], v[72:75], a[108:111], v[180:183]
  ds_read_b64_tr_b16 v[66:67], v10 offset:51200
  v_mfma_f32_16x16x32_bf16 v[184:187], v[76:79], a[104:107], v[184:187]
  ds_read_b64_tr_b16 v[68:69], v10 offset:57344
  v_mfma_f32_16x16x32_bf16 v[188:191], v[76:79], a[108:111], v[188:191]
  ds_read_b64_tr_b16 v[70:71], v10 offset:59392
  s_waitcnt lgkmcnt(8)
  v_mfma_f32_16x16x32_bf16 v[128:131], v[48:51], a[112:115], v[128:131]
  ds_read_b64_tr_b16 v[72:73], v11 offset:49152
  v_mfma_f32_16x16x32_bf16 v[132:135], v[48:51], a[116:119], v[132:135]
  ds_read_b64_tr_b16 v[74:75], v11 offset:51200
  v_mfma_f32_16x16x32_bf16 v[136:139], v[52:55], a[112:115], v[136:139]
  ds_read_b64_tr_b16 v[76:77], v11 offset:57344
  v_mfma_f32_16x16x32_bf16 v[140:143], v[52:55], a[116:119], v[140:143]
  ds_read_b64_tr_b16 v[78:79], v11 offset:59392
  s_waitcnt lgkmcnt(8)
  v_mfma_f32_16x16x32_bf16 v[144:147], v[56:59], a[112:115], v[144:147]
  ds_read_b64_tr_b16 v[48:49], v8 offset:53248
  v_mfma_f32_16x16x32_bf16 v[148:151], v[56:59], a[116:119], v[148:151]
  ds_read_b64_tr_b16 v[50:51], v8 offset:55296
  v_mfma_f32_16x16x32_bf16 v[152:155], v[60:63], a[112:115], v[152:155]
  ds_read_b64_tr_b16 v[52:53], v8 offset:61440
  v_mfma_f32_16x16x32_bf16 v[156:159], v[60:63], a[116:119], v[156:159]
  ds_read_b64_tr_b16 v[54:55], v8 offset:63488
  s_waitcnt lgkmcnt(8)
  v_mfma_f32_16x16x32_bf16 v[160:163], v[64:67], a[112:115], v[160:163]
  ds_read_b64_tr_b16 v[56:57], v9 offset:53248
  v_mfma_f32_16x16x32_bf16 v[164:167], v[64:67], a[116:119], v[164:167]
  ds_read_b64_tr_b16 v[58:59], v9 offset:55296
  v_mfma_f32_16x16x32_bf16 v[168:171], v[68:71], a[112:115], v[168:171]
  ds_read_b64_tr_b16 v[60:61], v9 offset:61440
  v_mfma_f32_16x16x32_bf16 v[172:175], v[68:71], a[116:119], v[172:175]
  ds_read_b64_tr_b16 v[62:63], v9 offset:63488
  s_waitcnt lgkmcnt(8)
  v_mfma_f32_16x16x32_bf16 v[176:179], v[72:75], a[112:115], v[176:179]
  ds_read_b64_tr_b16 v[64:65], v10 offset:53248
  v_mfma_f32_16x16x32_bf16 v[180:183], v[72:75], a[116:119], v[180:183]
  ds_read_b64_tr_b16 v[66:67], v10 offset:55296
  v_mfma_f32_16x16x32_bf16 v[184:187], v[76:79], a[112:115], v[184:187]
  ds_read_b64_tr_b16 v[68:69], v10 offset:61440
  v_mfma_f32_16x16x32_bf16 v[188:191], v[76:79], a[116:119], v[188:191]
  ds_read_b64_tr_b16 v[70:71], v10 offset:63488
  s_waitcnt lgkmcnt(8)
  v_mfma_f32_16x16x32_bf16 v[128:131], v[48:51], a[120:123], v[128:131]
  ds_read_b64_tr_b16 v[72:73], v11 offset:53248
  v_mfma_f32_16x16x32_bf16 v[132:135], v[48:51], a[124:127], v[132:135]
  ds_read_b64_tr_b16 v[74:75], v11 offset:55296
  v_mfma_f32_16x16x32_bf16 v[136:139], v[52:55], a[120:123], v[136:139]
  ds_read_b64_tr_b16 v[76:77], v11 offset:61440
  v_mfma_f32_16x16x32_bf16 v[140:143], v[52:55], a[124:127], v[140:143]
  ds_read_b64_tr_b16 v[78:79], v11 offset:63488
  v_subrev_u32 v8, 0x10000, v8
  v_subrev_u32 v9, 0x10000, v9
  v_subrev_u32 v10, 0x10000, v10
  s_waitcnt vmcnt(0)
  s_barrier
  s_waitcnt lgkmcnt(8)
  v_mfma_f32_16x16x32_bf16 v[144:147], v[56:59], a[120:123], v[144:147]
  ds_read_b64_tr_b16 v[48:49], v8 offset:0
  v_mfma_f32_16x16x32_bf16 v[148:151], v[56:59], a[124:127], v[148:151]
  ds_read_b64_tr_b16 v[50:51], v8 offset:2048
  s_mov_b32 s100, 1146880
  s_add_u32 m0, s86, 81920
  s_nop 0
  buffer_load_dwordx4 v12, s[88:91], s100 offen offset:0 lds
  v_mfma_f32_16x16x32_bf16 v[152:155], v[60:63], a[120:123], v[152:155]
  ds_read_b64_tr_b16 v[52:53], v8 offset:8192
  v_mfma_f32_16x16x32_bf16 v[156:159], v[60:63], a[124:127], v[156:159]
  ds_read_b64_tr_b16 v[54:55], v8 offset:10240
  s_waitcnt lgkmcnt(8)
  v_mfma_f32_16x16x32_bf16 v[160:163], v[64:67], a[120:123], v[160:163]
  ds_read_b64_tr_b16 v[56:57], v9 offset:0
  v_mfma_f32_16x16x32_bf16 v[164:167], v[64:67], a[124:127], v[164:167]
  ds_read_b64_tr_b16 v[58:59], v9 offset:2048
  buffer_load_dwordx4 v13, s[88:91], s100 offen offset:1024 lds
  v_mfma_f32_16x16x32_bf16 v[168:171], v[68:71], a[120:123], v[168:171]
  ds_read_b64_tr_b16 v[60:61], v9 offset:8192
  v_mfma_f32_16x16x32_bf16 v[172:175], v[68:71], a[124:127], v[172:175]
  ds_read_b64_tr_b16 v[62:63], v9 offset:10240
  s_waitcnt lgkmcnt(8)
  v_mfma_f32_16x16x32_bf16 v[176:179], v[72:75], a[120:123], v[176:179]
  ds_read_b64_tr_b16 v[64:65], v10 offset:0
  v_mfma_f32_16x16x32_bf16 v[180:183], v[72:75], a[124:127], v[180:183]
  ds_read_b64_tr_b16 v[66:67], v10 offset:2048
  buffer_load_dwordx4 v17, s[88:91], s100 offen offset:2048 lds
  v_mfma_f32_16x16x32_bf16 v[184:187], v[76:79], a[120:123], v[184:187]
  ds_read_b64_tr_b16 v[68:69], v10 offset:8192
  v_mfma_f32_16x16x32_bf16 v[188:191], v[76:79], a[124:127], v[188:191]
  ds_read_b64_tr_b16 v[70:71], v10 offset:10240
  s_mov_b32 s58, 0xbfb8aa3b
  v_pk_mul_f32 v[36:37], v[128:129], s[58:59] op_sel_hi:[1,0]
  v_pk_mul_f32 v[38:39], v[130:131], s[58:59] op_sel_hi:[1,0]
  v_pk_mul_f32 v[40:41], v[132:133], s[58:59] op_sel_hi:[1,0]
  v_pk_mul_f32 v[42:43], v[134:135], s[58:59] op_sel_hi:[1,0]
  v_exp_f32 v36, v36
  v_exp_f32 v37, v37
  v_exp_f32 v38, v38
  v_exp_f32 v39, v39
  v_exp_f32 v40, v40
  v_exp_f32 v41, v41
  v_exp_f32 v42, v42
  v_exp_f32 v43, v43
  v_pk_mul_f32 v[128:129], v[128:129], v[136:137]
  v_pk_mul_f32 v[130:131], v[130:131], v[138:139]
  v_pk_mul_f32 v[132:133], v[132:133], v[140:141]
  v_pk_mul_f32 v[134:135], v[134:135], v[142:143]
  v_pk_add_f32 v[36:37], v[36:37], 1.0 op_sel_hi:[1,0]
  v_pk_add_f32 v[38:39], v[38:39], 1.0 op_sel_hi:[1,0]
  v_pk_add_f32 v[40:41], v[40:41], 1.0 op_sel_hi:[1,0]
  v_pk_add_f32 v[42:43], v[42:43], 1.0 op_sel_hi:[1,0]
  v_rcp_f32 v36, v36
  v_rcp_f32 v37, v37
  v_rcp_f32 v38, v38
  v_rcp_f32 v39, v39
  v_rcp_f32 v40, v40
  v_rcp_f32 v41, v41
  v_rcp_f32 v42, v42
  v_rcp_f32 v43, v43
  v_pk_mul_f32 v[128:129], v[128:129], v[36:37]
  v_pk_mul_f32 v[130:131], v[130:131], v[38:39]
  v_pk_mul_f32 v[132:133], v[132:133], v[40:41]
  v_pk_mul_f32 v[134:135], v[134:135], v[42:43]
  v_cvt_pk_bf16_f32 v104, v128, v129
  v_cvt_pk_bf16_f32 v105, v130, v131
  v_cvt_pk_bf16_f32 v106, v132, v133
  v_cvt_pk_bf16_f32 v107, v134, v135
  s_nop 0
  v_permlane16_swap_b32 v104, v106
  v_permlane16_swap_b32 v105, v107
  s_add_u32 s57, s72, 0
  buffer_store_dwordx4 v[104:107], v3, s[4:7], s57 offen sc1
  v_pk_mul_f32 v[36:37], v[144:145], s[58:59] op_sel_hi:[1,0]
  v_pk_mul_f32 v[38:39], v[146:147], s[58:59] op_sel_hi:[1,0]
  v_pk_mul_f32 v[40:41], v[148:149], s[58:59] op_sel_hi:[1,0]
  v_pk_mul_f32 v[42:43], v[150:151], s[58:59] op_sel_hi:[1,0]
  v_exp_f32 v36, v36
  v_exp_f32 v37, v37
  v_exp_f32 v38, v38
  v_exp_f32 v39, v39
  v_exp_f32 v40, v40
  v_exp_f32 v41, v41
  v_exp_f32 v42, v42
  v_exp_f32 v43, v43
  v_pk_mul_f32 v[144:145], v[144:145], v[152:153]
  v_pk_mul_f32 v[146:147], v[146:147], v[154:155]
  v_pk_mul_f32 v[148:149], v[148:149], v[156:157]
  v_pk_mul_f32 v[150:151], v[150:151], v[158:159]
  v_pk_add_f32 v[36:37], v[36:37], 1.0 op_sel_hi:[1,0]
  v_pk_add_f32 v[38:39], v[38:39], 1.0 op_sel_hi:[1,0]
  v_pk_add_f32 v[40:41], v[40:41], 1.0 op_sel_hi:[1,0]
  v_pk_add_f32 v[42:43], v[42:43], 1.0 op_sel_hi:[1,0]
  v_rcp_f32 v36, v36
  v_rcp_f32 v37, v37
  v_rcp_f32 v38, v38
  v_rcp_f32 v39, v39
  v_rcp_f32 v40, v40
  v_rcp_f32 v41, v41
  v_rcp_f32 v42, v42
  v_rcp_f32 v43, v43
  v_pk_mul_f32 v[144:145], v[144:145], v[36:37]
  v_pk_mul_f32 v[146:147], v[146:147], v[38:39]
  v_pk_mul_f32 v[148:149], v[148:149], v[40:41]
  v_pk_mul_f32 v[150:151], v[150:151], v[42:43]
  v_cvt_pk_bf16_f32 v108, v144, v145
  v_cvt_pk_bf16_f32 v109, v146, v147
  v_cvt_pk_bf16_f32 v110, v148, v149
  v_cvt_pk_bf16_f32 v111, v150, v151
  s_nop 0
  v_permlane16_swap_b32 v108, v110
  v_permlane16_swap_b32 v109, v111
  s_add_u32 s57, s72, 512
  buffer_store_dwordx4 v[108:111], v3, s[4:7], s57 offen sc1
  v_pk_mul_f32 v[36:37], v[160:161], s[58:59] op_sel_hi:[1,0]
  v_pk_mul_f32 v[38:39], v[162:163], s[58:59] op_sel_hi:[1,0]
  v_pk_mul_f32 v[40:41], v[164:165], s[58:59] op_sel_hi:[1,0]
  v_pk_mul_f32 v[42:43], v[166:167], s[58:59] op_sel_hi:[1,0]
  v_exp_f32 v36, v36
  v_exp_f32 v37, v37
  v_exp_f32 v38, v38
  v_exp_f32 v39, v39
  v_exp_f32 v40, v40
  v_exp_f32 v41, v41
  v_exp_f32 v42, v42
  v_exp_f32 v43, v43
  v_pk_mul_f32 v[160:161], v[160:161], v[168:169]
  v_pk_mul_f32 v[162:163], v[162:163], v[170:171]
  v_pk_mul_f32 v[164:165], v[164:165], v[172:173]
  v_pk_mul_f32 v[166:167], v[166:167], v[174:175]
  v_pk_add_f32 v[36:37], v[36:37], 1.0 op_sel_hi:[1,0]
  v_pk_add_f32 v[38:39], v[38:39], 1.0 op_sel_hi:[1,0]
  v_pk_add_f32 v[40:41], v[40:41], 1.0 op_sel_hi:[1,0]
  v_pk_add_f32 v[42:43], v[42:43], 1.0 op_sel_hi:[1,0]
  v_rcp_f32 v36, v36
  v_rcp_f32 v37, v37
  v_rcp_f32 v38, v38
  v_rcp_f32 v39, v39
  v_rcp_f32 v40, v40
  v_rcp_f32 v41, v41
  v_rcp_f32 v42, v42
  v_rcp_f32 v43, v43
  v_pk_mul_f32 v[160:161], v[160:161], v[36:37]
  v_pk_mul_f32 v[162:163], v[162:163], v[38:39]
  v_pk_mul_f32 v[164:165], v[164:165], v[40:41]
  v_pk_mul_f32 v[166:167], v[166:167], v[42:43]
  v_cvt_pk_bf16_f32 v104, v160, v161
  v_cvt_pk_bf16_f32 v105, v162, v163
  v_cvt_pk_bf16_f32 v106, v164, v165
  v_cvt_pk_bf16_f32 v107, v166, v167
  s_nop 0
  v_permlane16_swap_b32 v104, v106
  v_permlane16_swap_b32 v105, v107
  s_add_u32 s57, s72, 1024
  buffer_store_dwordx4 v[104:107], v3, s[4:7], s57 offen sc1
  v_pk_mul_f32 v[36:37], v[176:177], s[58:59] op_sel_hi:[1,0]
  v_pk_mul_f32 v[38:39], v[178:179], s[58:59] op_sel_hi:[1,0]
  v_pk_mul_f32 v[40:41], v[180:181], s[58:59] op_sel_hi:[1,0]
  v_pk_mul_f32 v[42:43], v[182:183], s[58:59] op_sel_hi:[1,0]
  v_exp_f32 v36, v36
  v_exp_f32 v37, v37
  v_exp_f32 v38, v38
  v_exp_f32 v39, v39
  v_exp_f32 v40, v40
  v_exp_f32 v41, v41
  v_exp_f32 v42, v42
  v_exp_f32 v43, v43
  v_pk_mul_f32 v[176:177], v[176:177], v[184:185]
  v_pk_mul_f32 v[178:179], v[178:179], v[186:187]
  v_pk_mul_f32 v[180:181], v[180:181], v[188:189]
  v_pk_mul_f32 v[182:183], v[182:183], v[190:191]
  v_pk_add_f32 v[36:37], v[36:37], 1.0 op_sel_hi:[1,0]
  v_pk_add_f32 v[38:39], v[38:39], 1.0 op_sel_hi:[1,0]
  v_pk_add_f32 v[40:41], v[40:41], 1.0 op_sel_hi:[1,0]
  v_pk_add_f32 v[42:43], v[42:43], 1.0 op_sel_hi:[1,0]
  v_rcp_f32 v36, v36
  v_rcp_f32 v37, v37
  v_rcp_f32 v38, v38
  v_rcp_f32 v39, v39
  v_rcp_f32 v40, v40
  v_rcp_f32 v41, v41
  v_rcp_f32 v42, v42
  v_rcp_f32 v43, v43
  v_pk_mul_f32 v[176:177], v[176:177], v[36:37]
  v_pk_mul_f32 v[178:179], v[178:179], v[38:39]
  v_pk_mul_f32 v[180:181], v[180:181], v[40:41]
  v_pk_mul_f32 v[182:183], v[182:183], v[42:43]
  v_cvt_pk_bf16_f32 v108, v176, v177
  v_cvt_pk_bf16_f32 v109, v178, v179
  v_cvt_pk_bf16_f32 v110, v180, v181
  v_cvt_pk_bf16_f32 v111, v182, v183
  s_nop 0
  v_permlane16_swap_b32 v108, v110
  v_permlane16_swap_b32 v109, v111
  s_add_u32 s57, s72, 1536
  buffer_store_dwordx4 v[108:111], v3, s[4:7], s57 offen sc1
  s_waitcnt lgkmcnt(8)
  v_mfma_f32_16x16x32_bf16 v[192:195], v[48:51], a[0:3], 0
  ds_read_b64_tr_b16 v[72:73], v8 offset:4096
  v_mfma_f32_16x16x32_bf16 v[196:199], v[48:51], a[4:7], 0
  ds_read_b64_tr_b16 v[74:75], v8 offset:6144
  buffer_load_dwordx4 v18, s[88:91], s100 offen offset:3072 lds
  v_mfma_f32_16x16x32_bf16 v[200:203], v[52:55], a[0:3], 0
  ds_read_b64_tr_b16 v[76:77], v8 offset:12288
  v_mfma_f32_16x16x32_bf16 v[204:207], v[52:55], a[4:7], 0
  ds_read_b64_tr_b16 v[78:79], v8 offset:14336
  s_waitcnt lgkmcnt(8)
  v_mfma_f32_16x16x32_bf16 v[208:211], v[56:59], a[0:3], 0
  ds_read_b64_tr_b16 v[48:49], v9 offset:4096
  v_mfma_f32_16x16x32_bf16 v[212:215], v[56:59], a[4:7], 0
  ds_read_b64_tr_b16 v[50:51], v9 offset:6144
  s_mov_b32 s100, 1376256
  s_add_u32 m0, s86, 98304
  s_nop 0
  buffer_load_dwordx4 v12, s[88:91], s100 offen offset:0 lds
  v_mfma_f32_16x16x32_bf16 v[216:219], v[60:63], a[0:3], 0
  ds_read_b64_tr_b16 v[52:53], v9 offset:12288
  v_mfma_f32_16x16x32_bf16 v[220:223], v[60:63], a[4:7], 0
  ds_read_b64_tr_b16 v[54:55], v9 offset:14336
  s_waitcnt lgkmcnt(8)
  v_mfma_f32_16x16x32_bf16 v[224:227], v[64:67], a[0:3], 0
  ds_read_b64_tr_b16 v[56:57], v10 offset:4096
  v_mfma_f32_16x16x32_bf16 v[228:231], v[64:67], a[4:7], 0
  ds_read_b64_tr_b16 v[58:59], v10 offset:6144
  buffer_load_dwordx4 v13, s[88:91], s100 offen offset:1024 lds
  v_mfma_f32_16x16x32_bf16 v[232:235], v[68:71], a[0:3], 0
  ds_read_b64_tr_b16 v[60:61], v10 offset:12288
  v_mfma_f32_16x16x32_bf16 v[236:239], v[68:71], a[4:7], 0
  ds_read_b64_tr_b16 v[62:63], v10 offset:14336
  s_waitcnt lgkmcnt(8)
  v_mfma_f32_16x16x32_bf16 v[192:195], v[72:75], a[8:11], v[192:195]
  ds_read_b64_tr_b16 v[64:65], v8 offset:16384
  v_mfma_f32_16x16x32_bf16 v[196:199], v[72:75], a[12:15], v[196:199]
  ds_read_b64_tr_b16 v[66:67], v8 offset:18432
  buffer_load_dwordx4 v17, s[88:91], s100 offen offset:2048 lds
  v_mfma_f32_16x16x32_bf16 v[200:203], v[76:79], a[8:11], v[200:203]
  ds_read_b64_tr_b16 v[68:69], v8 offset:24576
  v_mfma_f32_16x16x32_bf16 v[204:207], v[76:79], a[12:15], v[204:207]
  ds_read_b64_tr_b16 v[70:71], v8 offset:26624
  s_waitcnt lgkmcnt(8)
  v_mfma_f32_16x16x32_bf16 v[208:211], v[48:51], a[8:11], v[208:211]
  ds_read_b64_tr_b16 v[72:73], v9 offset:16384
  v_mfma_f32_16x16x32_bf16 v[212:215], v[48:51], a[12:15], v[212:215]
  ds_read_b64_tr_b16 v[74:75], v9 offset:18432
  buffer_load_dwordx4 v18, s[88:91], s100 offen offset:3072 lds
  v_mfma_f32_16x16x32_bf16 v[216:219], v[52:55], a[8:11], v[216:219]
  ds_read_b64_tr_b16 v[76:77], v9 offset:24576
  v_mfma_f32_16x16x32_bf16 v[220:223], v[52:55], a[12:15], v[220:223]
  ds_read_b64_tr_b16 v[78:79], v9 offset:26624
  s_waitcnt lgkmcnt(8)
  v_mfma_f32_16x16x32_bf16 v[224:227], v[56:59], a[8:11], v[224:227]
  ds_read_b64_tr_b16 v[48:49], v10 offset:16384
  v_mfma_f32_16x16x32_bf16 v[228:231], v[56:59], a[12:15], v[228:231]
  ds_read_b64_tr_b16 v[50:51], v10 offset:18432
  v_mfma_f32_16x16x32_bf16 v[232:235], v[60:63], a[8:11], v[232:235]
  ds_read_b64_tr_b16 v[52:53], v10 offset:24576
  v_mfma_f32_16x16x32_bf16 v[236:239], v[60:63], a[12:15], v[236:239]
  ds_read_b64_tr_b16 v[54:55], v10 offset:26624
  s_waitcnt lgkmcnt(8)
  v_mfma_f32_16x16x32_bf16 v[192:195], v[64:67], a[16:19], v[192:195]
  ds_read_b64_tr_b16 v[56:57], v8 offset:20480
  v_mfma_f32_16x16x32_bf16 v[196:199], v[64:67], a[20:23], v[196:199]
  ds_read_b64_tr_b16 v[58:59], v8 offset:22528
  v_mfma_f32_16x16x32_bf16 v[200:203], v[68:71], a[16:19], v[200:203]
  ds_read_b64_tr_b16 v[60:61], v8 offset:28672
  v_mfma_f32_16x16x32_bf16 v[204:207], v[68:71], a[20:23], v[204:207]
  ds_read_b64_tr_b16 v[62:63], v8 offset:30720
  s_waitcnt lgkmcnt(8)
  v_mfma_f32_16x16x32_bf16 v[208:211], v[72:75], a[16:19], v[208:211]
  ds_read_b64_tr_b16 v[64:65], v9 offset:20480
  v_mfma_f32_16x16x32_bf16 v[212:215], v[72:75], a[20:23], v[212:215]
  ds_read_b64_tr_b16 v[66:67], v9 offset:22528
  v_mfma_f32_16x16x32_bf16 v[216:219], v[76:79], a[16:19], v[216:219]
  ds_read_b64_tr_b16 v[68:69], v9 offset:28672
  v_mfma_f32_16x16x32_bf16 v[220:223], v[76:79], a[20:23], v[220:223]
  ds_read_b64_tr_b16 v[70:71], v9 offset:30720
  s_waitcnt lgkmcnt(8)
  v_mfma_f32_16x16x32_bf16 v[224:227], v[48:51], a[16:19], v[224:227]
  ds_read_b64_tr_b16 v[72:73], v10 offset:20480
  v_mfma_f32_16x16x32_bf16 v[228:231], v[48:51], a[20:23], v[228:231]
  ds_read_b64_tr_b16 v[74:75], v10 offset:22528
  v_mfma_f32_16x16x32_bf16 v[232:235], v[52:55], a[16:19], v[232:235]
  ds_read_b64_tr_b16 v[76:77], v10 offset:28672
  v_mfma_f32_16x16x32_bf16 v[236:239], v[52:55], a[20:23], v[236:239]
  ds_read_b64_tr_b16 v[78:79], v10 offset:30720
  s_waitcnt vmcnt(5)
  s_barrier
  s_cmp_lg_u32 s3, 0
  s_cbranch_scc1 X4A_S
  s_lshl_b32 s57, s47, 7
  s_lshl_b32 s56, s63, 2
  s_add_u32 s57, s57, s56
  s_add_u32 s57, s57, 4096
  v_mov_b32 v4, 0x40000000
  v_mov_b32 v5, 1
  v_writelane_b32 v4, s57, 0
  buffer_store_dword v5, v4, s[80:83], 0 offen sc1
X4A_S:
  s_waitcnt lgkmcnt(8)
  v_mfma_f32_16x16x32_bf16 v[192:195], v[56:59], a[24:27], v[192:195]
  ds_read_b64_tr_b16 v[48:49], v8 offset:32768
  v_mfma_f32_16x16x32_bf16 v[196:199], v[56:59], a[28:31], v[196:199]
  ds_read_b64_tr_b16 v[50:51], v8 offset:34816
  s_mov_b32 s100, 1605632
  s_add_u32 m0, s86, 114688
  s_nop 0
  buffer_load_dwordx4 v12, s[88:91], s100 offen offset:0 lds
  v_mfma_f32_16x16x32_bf16 v[200:203], v[60:63], a[24:27], v[200:203]
  ds_read_b64_tr_b16 v[52:53], v8 offset:40960
  v_mfma_f32_16x16x32_bf16 v[204:207], v[60:63], a[28:31], v[204:207]
  ds_read_b64_tr_b16 v[54:55], v8 offset:43008
  s_waitcnt lgkmcnt(8)
  v_mfma_f32_16x16x32_bf16 v[208:211], v[64:67], a[24:27], v[208:211]
  ds_read_b64_tr_b16 v[56:57], v9 offset:32768
  v_mfma_f32_16x16x32_bf16 v[212:215], v[64:67], a[28:31], v[212:215]
  ds_read_b64_tr_b16 v[58:59], v9 offset:34816
  buffer_load_dwordx4 v13, s[88:91], s100 offen offset:1024 lds
  v_mfma_f32_16x16x32_bf16 v[216:219], v[68:71], a[24:27], v[216:219]
  ds_read_b64_tr_b16 v[60:61], v9 offset:40960
  v_mfma_f32_16x16x32_bf16 v[220:223], v[68:71], a[28:31], v[220:223]
  ds_read_b64_tr_b16 v[62:63], v9 offset:43008
  s_waitcnt lgkmcnt(8)
  v_mfma_f32_16x16x32_bf16 v[224:227], v[72:75], a[24:27], v[224:227]
  ds_read_b64_tr_b16 v[64:65], v10 offset:32768
  v_mfma_f32_16x16x32_bf16 v[228:231], v[72:75], a[28:31], v[228:231]
  ds_read_b64_tr_b16 v[66:67], v10 offset:34816
  buffer_load_dwordx4 v17, s[88:91], s100 offen offset:2048 lds
  v_mfma_f32_16x16x32_bf16 v[232:235], v[76:79], a[24:27], v[232:235]
  ds_read_b64_tr_b16 v[68:69], v10 offset:40960
  v_mfma_f32_16x16x32_bf16 v[236:239], v[76:79], a[28:31], v[236:239]
  ds_read_b64_tr_b16 v[70:71], v10 offset:43008
  s_waitcnt lgkmcnt(8)
  v_mfma_f32_16x16x32_bf16 v[192:195], v[48:51], a[32:35], v[192:195]
  ds_read_b64_tr_b16 v[72:73], v8 offset:36864
  v_mfma_f32_16x16x32_bf16 v[196:199], v[48:51], a[36:39], v[196:199]
  ds_read_b64_tr_b16 v[74:75], v8 offset:38912
  buffer_load_dwordx4 v18, s[88:91], s100 offen offset:3072 lds
  v_mfma_f32_16x16x32_bf16 v[200:203], v[52:55], a[32:35], v[200:203]
  ds_read_b64_tr_b16 v[76:77], v8 offset:45056
  v_mfma_f32_16x16x32_bf16 v[204:207], v[52:55], a[36:39], v[204:207]
  ds_read_b64_tr_b16 v[78:79], v8 offset:47104
  s_waitcnt lgkmcnt(8)
  v_mfma_f32_16x16x32_bf16 v[208:211], v[56:59], a[32:35], v[208:211]
  ds_read_b64_tr_b16 v[48:49], v9 offset:36864
  v_mfma_f32_16x16x32_bf16 v[212:215], v[56:59], a[36:39], v[212:215]
  ds_read_b64_tr_b16 v[50:51], v9 offset:38912
  s_add_u32 m0, s60, 0
  s_add_u32 s99, s96, 229376
  buffer_load_dwordx4 v247, s[52:55], s99 offen offset:0 lds
  v_mfma_f32_16x16x32_bf16 v[216:219], v[60:63], a[32:35], v[216:219]
  ds_read_b64_tr_b16 v[52:53], v9 offset:45056
  v_mfma_f32_16x16x32_bf16 v[220:223], v[60:63], a[36:39], v[220:223]
  ds_read_b64_tr_b16 v[54:55], v9 offset:47104
  s_waitcnt lgkmcnt(8)
  v_mfma_f32_16x16x32_bf16 v[224:227], v[64:67], a[32:35], v[224:227]
  ds_read_b64_tr_b16 v[56:57], v10 offset:36864
  v_mfma_f32_16x16x32_bf16 v[228:231], v[64:67], a[36:39], v[228:231]
  ds_read_b64_tr_b16 v[58:59], v10 offset:38912
  buffer_load_dwordx4 v248, s[52:55], s99 offen offset:1024 lds
  v_mfma_f32_16x16x32_bf16 v[232:235], v[68:71], a[32:35], v[232:235]
  ds_read_b64_tr_b16 v[60:61], v10 offset:45056
  v_mfma_f32_16x16x32_bf16 v[236:239], v[68:71], a[36:39], v[236:239]
  ds_read_b64_tr_b16 v[62:63], v10 offset:47104
  s_waitcnt lgkmcnt(8)
  v_mfma_f32_16x16x32_bf16 v[192:195], v[72:75], a[40:43], v[192:195]
  ds_read_b64_tr_b16 v[64:65], v8 offset:49152
  v_mfma_f32_16x16x32_bf16 v[196:199], v[72:75], a[44:47], v[196:199]
  ds_read_b64_tr_b16 v[66:67], v8 offset:51200
  buffer_load_dwordx4 v249, s[52:55], s99 offen offset:2048 lds
  v_mfma_f32_16x16x32_bf16 v[200:203], v[76:79], a[40:43], v[200:203]
  ds_read_b64_tr_b16 v[68:69], v8 offset:57344
  v_mfma_f32_16x16x32_bf16 v[204:207], v[76:79], a[44:47], v[204:207]
  ds_read_b64_tr_b16 v[70:71], v8 offset:59392
  s_waitcnt lgkmcnt(8)
  v_mfma_f32_16x16x32_bf16 v[208:211], v[48:51], a[40:43], v[208:211]
  ds_read_b64_tr_b16 v[72:73], v9 offset:49152
  v_mfma_f32_16x16x32_bf16 v[212:215], v[48:51], a[44:47], v[212:215]
  ds_read_b64_tr_b16 v[74:75], v9 offset:51200
  buffer_load_dwordx4 v250, s[52:55], s99 offen offset:3072 lds
  v_mfma_f32_16x16x32_bf16 v[216:219], v[52:55], a[40:43], v[216:219]
  ds_read_b64_tr_b16 v[76:77], v9 offset:57344
  v_mfma_f32_16x16x32_bf16 v[220:223], v[52:55], a[44:47], v[220:223]
  ds_read_b64_tr_b16 v[78:79], v9 offset:59392
  s_waitcnt lgkmcnt(8)
  v_mfma_f32_16x16x32_bf16 v[224:227], v[56:59], a[40:43], v[224:227]
  ds_read_b64_tr_b16 v[48:49], v10 offset:49152
  v_mfma_f32_16x16x32_bf16 v[228:231], v[56:59], a[44:47], v[228:231]
  ds_read_b64_tr_b16 v[50:51], v10 offset:51200
  s_add_u32 m0, s60, 4096
  s_add_u32 s99, s98, 0
  buffer_load_dwordx4 v247, s[52:55], s99 offen offset:0 lds
  v_mfma_f32_16x16x32_bf16 v[232:235], v[60:63], a[40:43], v[232:235]
  ds_read_b64_tr_b16 v[52:53], v10 offset:57344
  v_mfma_f32_16x16x32_bf16 v[236:239], v[60:63], a[44:47], v[236:239]
  ds_read_b64_tr_b16 v[54:55], v10 offset:59392
  s_waitcnt lgkmcnt(8)
  v_mfma_f32_16x16x32_bf16 v[192:195], v[64:67], a[48:51], v[192:195]
  ds_read_b64_tr_b16 v[56:57], v8 offset:53248
  v_mfma_f32_16x16x32_bf16 v[196:199], v[64:67], a[52:55], v[196:199]
  ds_read_b64_tr_b16 v[58:59], v8 offset:55296
  buffer_load_dwordx4 v248, s[52:55], s99 offen offset:1024 lds
  v_mfma_f32_16x16x32_bf16 v[200:203], v[68:71], a[48:51], v[200:203]
  ds_read_b64_tr_b16 v[60:61], v8 offset:61440
  v_mfma_f32_16x16x32_bf16 v[204:207], v[68:71], a[52:55], v[204:207]
  ds_read_b64_tr_b16 v[62:63], v8 offset:63488
  s_waitcnt lgkmcnt(8)
  v_mfma_f32_16x16x32_bf16 v[208:211], v[72:75], a[48:51], v[208:211]
  ds_read_b64_tr_b16 v[64:65], v9 offset:53248
  v_mfma_f32_16x16x32_bf16 v[212:215], v[72:75], a[52:55], v[212:215]
  ds_read_b64_tr_b16 v[66:67], v9 offset:55296
  buffer_load_dwordx4 v249, s[52:55], s99 offen offset:2048 lds
  v_mfma_f32_16x16x32_bf16 v[216:219], v[76:79], a[48:51], v[216:219]
  ds_read_b64_tr_b16 v[68:69], v9 offset:61440
  v_mfma_f32_16x16x32_bf16 v[220:223], v[76:79], a[52:55], v[220:223]
  ds_read_b64_tr_b16 v[70:71], v9 offset:63488
  s_waitcnt lgkmcnt(8)
  v_mfma_f32_16x16x32_bf16 v[224:227], v[48:51], a[48:51], v[224:227]
  ds_read_b64_tr_b16 v[72:73], v10 offset:53248
  v_mfma_f32_16x16x32_bf16 v[228:231], v[48:51], a[52:55], v[228:231]
  ds_read_b64_tr_b16 v[74:75], v10 offset:55296
  buffer_load_dwordx4 v250, s[52:55], s99 offen offset:3072 lds
  v_mfma_f32_16x16x32_bf16 v[232:235], v[52:55], a[48:51], v[232:235]
  ds_read_b64_tr_b16 v[76:77], v10 offset:61440
  v_mfma_f32_16x16x32_bf16 v[236:239], v[52:55], a[52:55], v[236:239]
  ds_read_b64_tr_b16 v[78:79], v10 offset:63488
  v_add_u32 v8, 0x10000, v8
  v_add_u32 v9, 0x10000, v9
  v_add_u32 v10, 0x10000, v10
  s_waitcnt lgkmcnt(8)
  v_mfma_f32_16x16x32_bf16 v[192:195], v[56:59], a[56:59], v[192:195]
  ds_read_b64_tr_b16 v[48:49], v8 offset:0
  v_mfma_f32_16x16x32_bf16 v[196:199], v[56:59], a[60:63], v[196:199]
  ds_read_b64_tr_b16 v[50:51], v8 offset:2048
  v_mfma_f32_16x16x32_bf16 v[200:203], v[60:63], a[56:59], v[200:203]
  ds_read_b64_tr_b16 v[52:53], v8 offset:8192
  v_mfma_f32_16x16x32_bf16 v[204:207], v[60:63], a[60:63], v[204:207]
  ds_read_b64_tr_b16 v[54:55], v8 offset:10240
  s_waitcnt lgkmcnt(8)
  v_mfma_f32_16x16x32_bf16 v[208:211], v[64:67], a[56:59], v[208:211]
  ds_read_b64_tr_b16 v[56:57], v9 offset:0
  v_mfma_f32_16x16x32_bf16 v[212:215], v[64:67], a[60:63], v[212:215]
  ds_read_b64_tr_b16 v[58:59], v9 offset:2048
  v_mfma_f32_16x16x32_bf16 v[216:219], v[68:71], a[56:59], v[216:219]
  ds_read_b64_tr_b16 v[60:61], v9 offset:8192
  v_mfma_f32_16x16x32_bf16 v[220:223], v[68:71], a[60:63], v[220:223]
  ds_read_b64_tr_b16 v[62:63], v9 offset:10240
  s_waitcnt lgkmcnt(8)
  v_mfma_f32_16x16x32_bf16 v[224:227], v[72:75], a[56:59], v[224:227]
  ds_read_b64_tr_b16 v[64:65], v10 offset:0
  v_mfma_f32_16x16x32_bf16 v[228:231], v[72:75], a[60:63], v[228:231]
  ds_read_b64_tr_b16 v[66:67], v10 offset:2048
  v_mfma_f32_16x16x32_bf16 v[232:235], v[76:79], a[56:59], v[232:235]
  ds_read_b64_tr_b16 v[68:69], v10 offset:8192
  v_mfma_f32_16x16x32_bf16 v[236:239], v[76:79], a[60:63], v[236:239]
  ds_read_b64_tr_b16 v[70:71], v10 offset:10240
  s_waitcnt lgkmcnt(8)
  v_mfma_f32_16x16x32_bf16 v[192:195], v[48:51], a[64:67], v[192:195]
  ds_read_b64_tr_b16 v[72:73], v8 offset:4096
  v_mfma_f32_16x16x32_bf16 v[196:199], v[48:51], a[68:71], v[196:199]
  ds_read_b64_tr_b16 v[74:75], v8 offset:6144
  v_mfma_f32_16x16x32_bf16 v[200:203], v[52:55], a[64:67], v[200:203]
  ds_read_b64_tr_b16 v[76:77], v8 offset:12288
  v_mfma_f32_16x16x32_bf16 v[204:207], v[52:55], a[68:71], v[204:207]
  ds_read_b64_tr_b16 v[78:79], v8 offset:14336
  s_waitcnt lgkmcnt(8)
  v_mfma_f32_16x16x32_bf16 v[208:211], v[56:59], a[64:67], v[208:211]
  ds_read_b64_tr_b16 v[48:49], v9 offset:4096
  v_mfma_f32_16x16x32_bf16 v[212:215], v[56:59], a[68:71], v[212:215]
  ds_read_b64_tr_b16 v[50:51], v9 offset:6144
  v_mfma_f32_16x16x32_bf16 v[216:219], v[60:63], a[64:67], v[216:219]
  ds_read_b64_tr_b16 v[52:53], v9 offset:12288
  v_mfma_f32_16x16x32_bf16 v[220:223], v[60:63], a[68:71], v[220:223]
  ds_read_b64_tr_b16 v[54:55], v9 offset:14336
  s_waitcnt lgkmcnt(8)
  v_mfma_f32_16x16x32_bf16 v[224:227], v[64:67], a[64:67], v[224:227]
  ds_read_b64_tr_b16 v[56:57], v10 offset:4096
  v_mfma_f32_16x16x32_bf16 v[228:231], v[64:67], a[68:71], v[228:231]
  ds_read_b64_tr_b16 v[58:59], v10 offset:6144
  v_mfma_f32_16x16x32_bf16 v[232:235], v[68:71], a[64:67], v[232:235]
  ds_read_b64_tr_b16 v[60:61], v10 offset:12288
  v_mfma_f32_16x16x32_bf16 v[236:239], v[68:71], a[68:71], v[236:239]
  ds_read_b64_tr_b16 v[62:63], v10 offset:14336
  s_waitcnt vmcnt(12)
  s_barrier
  s_waitcnt lgkmcnt(8)
  v_mfma_f32_16x16x32_bf16 v[192:195], v[72:75], a[72:75], v[192:195]
  ds_read_b64_tr_b16 v[64:65], v8 offset:16384
  v_mfma_f32_16x16x32_bf16 v[196:199], v[72:75], a[76:79], v[196:199]
  ds_read_b64_tr_b16 v[66:67], v8 offset:18432
  v_mfma_f32_16x16x32_bf16 v[200:203], v[76:79], a[72:75], v[200:203]
  ds_read_b64_tr_b16 v[68:69], v8 offset:24576
  v_mfma_f32_16x16x32_bf16 v[204:207], v[76:79], a[76:79], v[204:207]
  ds_read_b64_tr_b16 v[70:71], v8 offset:26624
  s_waitcnt lgkmcnt(8)
  v_mfma_f32_16x16x32_bf16 v[208:211], v[48:51], a[72:75], v[208:211]
  ds_read_b64_tr_b16 v[72:73], v9 offset:16384
  v_mfma_f32_16x16x32_bf16 v[212:215], v[48:51], a[76:79], v[212:215]
  ds_read_b64_tr_b16 v[74:75], v9 offset:18432
  v_mfma_f32_16x16x32_bf16 v[216:219], v[52:55], a[72:75], v[216:219]
  ds_read_b64_tr_b16 v[76:77], v9 offset:24576
  v_mfma_f32_16x16x32_bf16 v[220:223], v[52:55], a[76:79], v[220:223]
  ds_read_b64_tr_b16 v[78:79], v9 offset:26624
  s_lshr_b32 s57, s46, 4
  s_lshl_b32 s57, s57, 7
  s_add_u32 s57, s57, 4096
  s_cmp_eq_u32 s3, 0
  s_cselect_b32 s57, s57, 0x40000000
  v_and_b32 v28, 15, v1
  v_lshlrev_b32 v28, 2, v28
  v_add_u32 v28, s57, v28
  s_waitcnt lgkmcnt(8)
  v_mfma_f32_16x16x32_bf16 v[224:227], v[56:59], a[72:75], v[224:227]
  ds_read_b64_tr_b16 v[48:49], v10 offset:16384
  v_mfma_f32_16x16x32_bf16 v[228:231], v[56:59], a[76:79], v[228:231]
  ds_read_b64_tr_b16 v[50:51], v10 offset:18432
  buffer_load_dword v29, v28, s[80:83], 0 offen sc1
  v_mfma_f32_16x16x32_bf16 v[232:235], v[60:63], a[72:75], v[232:235]
  ds_read_b64_tr_b16 v[52:53], v10 offset:24576
  v_mfma_f32_16x16x32_bf16 v[236:239], v[60:63], a[76:79], v[236:239]
  ds_read_b64_tr_b16 v[54:55], v10 offset:26624
  s_waitcnt lgkmcnt(8)
  v_mfma_f32_16x16x32_bf16 v[192:195], v[64:67], a[80:83], v[192:195]
  ds_read_b64_tr_b16 v[56:57], v8 offset:20480
  v_mfma_f32_16x16x32_bf16 v[196:199], v[64:67], a[84:87], v[196:199]
  ds_read_b64_tr_b16 v[58:59], v8 offset:22528
  s_add_u32 m0, s75, 0
  s_add_u32 s99, s98, 32768
  buffer_load_dwordx4 v247, s[52:55], s99 offen offset:0 lds
  v_mfma_f32_16x16x32_bf16 v[200:203], v[68:71], a[80:83], v[200:203]
  ds_read_b64_tr_b16 v[60:61], v8 offset:28672
  v_mfma_f32_16x16x32_bf16 v[204:207], v[68:71], a[84:87], v[204:207]
  ds_read_b64_tr_b16 v[62:63], v8 offset:30720
  s_waitcnt lgkmcnt(8)
  v_mfma_f32_16x16x32_bf16 v[208:211], v[72:75], a[80:83], v[208:211]
  ds_read_b64_tr_b16 v[64:65], v9 offset:20480
  v_mfma_f32_16x16x32_bf16 v[212:215], v[72:75], a[84:87], v[212:215]
  ds_read_b64_tr_b16 v[66:67], v9 offset:22528
  buffer_load_dwordx4 v248, s[52:55], s99 offen offset:1024 lds
  v_mfma_f32_16x16x32_bf16 v[216:219], v[76:79], a[80:83], v[216:219]
  ds_read_b64_tr_b16 v[68:69], v9 offset:28672
  v_mfma_f32_16x16x32_bf16 v[220:223], v[76:79], a[84:87], v[220:223]
  ds_read_b64_tr_b16 v[70:71], v9 offset:30720
  s_waitcnt lgkmcnt(8)
  v_mfma_f32_16x16x32_bf16 v[224:227], v[48:51], a[80:83], v[224:227]
  ds_read_b64_tr_b16 v[72:73], v10 offset:20480
  v_mfma_f32_16x16x32_bf16 v[228:231], v[48:51], a[84:87], v[228:231]
  ds_read_b64_tr_b16 v[74:75], v10 offset:22528
  buffer_load_dwordx4 v249, s[52:55], s99 offen offset:2048 lds
  v_mfma_f32_16x16x32_bf16 v[232:235], v[52:55], a[80:83], v[232:235]
  ds_read_b64_tr_b16 v[76:77], v10 offset:28672
  v_mfma_f32_16x16x32_bf16 v[236:239], v[52:55], a[84:87], v[236:239]
  ds_read_b64_tr_b16 v[78:79], v10 offset:30720
  s_waitcnt lgkmcnt(8)
  v_mfma_f32_16x16x32_bf16 v[192:195], v[56:59], a[88:91], v[192:195]
  ds_read_b64_tr_b16 v[48:49], v8 offset:32768
  v_mfma_f32_16x16x32_bf16 v[196:199], v[56:59], a[92:95], v[196:199]
  ds_read_b64_tr_b16 v[50:51], v8 offset:34816
  buffer_load_dwordx4 v250, s[52:55], s99 offen offset:3072 lds
  v_mfma_f32_16x16x32_bf16 v[200:203], v[60:63], a[88:91], v[200:203]
  ds_read_b64_tr_b16 v[52:53], v8 offset:40960
  v_mfma_f32_16x16x32_bf16 v[204:207], v[60:63], a[92:95], v[204:207]
  ds_read_b64_tr_b16 v[54:55], v8 offset:43008
  s_waitcnt lgkmcnt(8)
  v_mfma_f32_16x16x32_bf16 v[208:211], v[64:67], a[88:91], v[208:211]
  ds_read_b64_tr_b16 v[56:57], v9 offset:32768
  v_mfma_f32_16x16x32_bf16 v[212:215], v[64:67], a[92:95], v[212:215]
  ds_read_b64_tr_b16 v[58:59], v9 offset:34816
  s_add_u32 m0, s75, 4096
  s_add_u32 s99, s98, 65536
  buffer_load_dwordx4 v247, s[52:55], s99 offen offset:0 lds
  v_mfma_f32_16x16x32_bf16 v[216:219], v[68:71], a[88:91], v[216:219]
  ds_read_b64_tr_b16 v[60:61], v9 offset:40960
  v_mfma_f32_16x16x32_bf16 v[220:223], v[68:71], a[92:95], v[220:223]
  ds_read_b64_tr_b16 v[62:63], v9 offset:43008
  s_waitcnt lgkmcnt(8)
  v_mfma_f32_16x16x32_bf16 v[224:227], v[72:75], a[88:91], v[224:227]
  ds_read_b64_tr_b16 v[64:65], v10 offset:32768
  v_mfma_f32_16x16x32_bf16 v[228:231], v[72:75], a[92:95], v[228:231]
  ds_read_b64_tr_b16 v[66:67], v10 offset:34816
  buffer_load_dwordx4 v248, s[52:55], s99 offen offset:1024 lds
  v_mfma_f32_16x16x32_bf16 v[232:235], v[76:79], a[88:91], v[232:235]
  ds_read_b64_tr_b16 v[68:69], v10 offset:40960
  v_mfma_f32_16x16x32_bf16 v[236:239], v[76:79], a[92:95], v[236:239]
  ds_read_b64_tr_b16 v[70:71], v10 offset:43008
  s_waitcnt lgkmcnt(8)
  v_mfma_f32_16x16x32_bf16 v[192:195], v[48:51], a[96:99], v[192:195]
  ds_read_b64_tr_b16 v[72:73], v8 offset:36864
  v_mfma_f32_16x16x32_bf16 v[196:199], v[48:51], a[100:103], v[196:199]
  ds_read_b64_tr_b16 v[74:75], v8 offset:38912
  buffer_load_dwordx4 v249, s[52:55], s99 offen offset:2048 lds
  v_mfma_f32_16x16x32_bf16 v[200:203], v[52:55], a[96:99], v[200:203]
  ds_read_b64_tr_b16 v[76:77], v8 offset:45056
  v_mfma_f32_16x16x32_bf16 v[204:207], v[52:55], a[100:103], v[204:207]
  ds_read_b64_tr_b16 v[78:79], v8 offset:47104
  s_waitcnt lgkmcnt(8)
  v_mfma_f32_16x16x32_bf16 v[208:211], v[56:59], a[96:99], v[208:211]
  ds_read_b64_tr_b16 v[48:49], v9 offset:36864
  v_mfma_f32_16x16x32_bf16 v[212:215], v[56:59], a[100:103], v[212:215]
  ds_read_b64_tr_b16 v[50:51], v9 offset:38912
  buffer_load_dwordx4 v250, s[52:55], s99 offen offset:3072 lds
  v_mfma_f32_16x16x32_bf16 v[216:219], v[60:63], a[96:99], v[216:219]
  ds_read_b64_tr_b16 v[52:53], v9 offset:45056
  v_mfma_f32_16x16x32_bf16 v[220:223], v[60:63], a[100:103], v[220:223]
  ds_read_b64_tr_b16 v[54:55], v9 offset:47104
  s_waitcnt lgkmcnt(8)
  v_mfma_f32_16x16x32_bf16 v[224:227], v[64:67], a[96:99], v[224:227]
  ds_read_b64_tr_b16 v[56:57], v10 offset:36864
  v_mfma_f32_16x16x32_bf16 v[228:231], v[64:67], a[100:103], v[228:231]
  ds_read_b64_tr_b16 v[58:59], v10 offset:38912
  s_add_u32 m0, s75, 8192
  s_add_u32 s99, s98, 98304
  buffer_load_dwordx4 v247, s[52:55], s99 offen offset:0 lds
  v_mfma_f32_16x16x32_bf16 v[232:235], v[68:71], a[96:99], v[232:235]
  ds_read_b64_tr_b16 v[60:61], v10 offset:45056
  v_mfma_f32_16x16x32_bf16 v[236:239], v[68:71], a[100:103], v[236:239]
  ds_read_b64_tr_b16 v[62:63], v10 offset:47104
  s_waitcnt vmcnt(9)
  s_cmp_lg_u32 s3, 0
  s_cbranch_scc1 X4A_OK
  v_cmp_gt_u32 vcc, 1, v29
  s_nop 3
  s_cbranch_vccz X4A_OK
  s_mov_b32 s56, 0
  buffer_load_dword v29, v28, s[80:83], 0 offen sc1
POLL9:
  buffer_load_dword v30, v28, s[80:83], 0 offen sc1
  s_waitcnt vmcnt(1)
  v_cmp_gt_u32 vcc, 1, v29
  s_nop 3
  s_cbranch_vccz POLLD10
  buffer_load_dword v29, v28, s[80:83], 0 offen sc1
  s_waitcnt vmcnt(1)
  v_cmp_gt_u32 vcc, 1, v30
  s_nop 3
  s_cbranch_vccz POLLD10
  s_add_u32 s56, s56, 1
  s_cmp_lt_u32 s56, 400000
  s_cbranch_scc1 POLL9
POLLD10:
  s_waitcnt vmcnt(0)
X4A_OK:
  s_barrier
  s_waitcnt lgkmcnt(8)
  v_mfma_f32_16x16x32_bf16 v[192:195], v[72:75], a[104:107], v[192:195]
  ds_read_b64_tr_b16 v[64:65], v8 offset:49152
  v_mfma_f32_16x16x32_bf16 v[196:199], v[72:75], a[108:111], v[196:199]
  ds_read_b64_tr_b16 v[66:67], v8 offset:51200
  buffer_load_dwordx4 v248, s[52:55], s99 offen offset:1024 lds
  v_mfma_f32_16x16x32_bf16 v[200:203], v[76:79], a[104:107], v[200:203]
  ds_read_b64_tr_b16 v[68:69], v8 offset:57344
  v_mfma_f32_16x16x32_bf16 v[204:207], v[76:79], a[108:111], v[204:207]
  ds_read_b64_tr_b16 v[70:71], v8 offset:59392
  s_waitcnt lgkmcnt(8)
  v_mfma_f32_16x16x32_bf16 v[208:211], v[48:51], a[104:107], v[208:211]
  ds_read_b64_tr_b16 v[72:73], v9 offset:49152
  v_mfma_f32_16x16x32_bf16 v[212:215], v[48:51], a[108:111], v[212:215]
  ds_read_b64_tr_b16 v[74:75], v9 offset:51200
  buffer_load_dwordx4 v249, s[52:55], s99 offen offset:2048 lds
  v_mfma_f32_16x16x32_bf16 v[216:219], v[52:55], a[104:107], v[216:219]
  ds_read_b64_tr_b16 v[76:77], v9 offset:57344
  v_mfma_f32_16x16x32_bf16 v[220:223], v[52:55], a[108:111], v[220:223]
  ds_read_b64_tr_b16 v[78:79], v9 offset:59392
  s_waitcnt lgkmcnt(8)
  v_mfma_f32_16x16x32_bf16 v[224:227], v[56:59], a[104:107], v[224:227]
  ds_read_b64_tr_b16 v[48:49], v10 offset:49152
  v_mfma_f32_16x16x32_bf16 v[228:231], v[56:59], a[108:111], v[228:231]
  ds_read_b64_tr_b16 v[50:51], v10 offset:51200
  buffer_load_dwordx4 v250, s[52:55], s99 offen offset:3072 lds
  v_mfma_f32_16x16x32_bf16 v[232:235], v[60:63], a[104:107], v[232:235]
  ds_read_b64_tr_b16 v[52:53], v10 offset:57344
  v_mfma_f32_16x16x32_bf16 v[236:239], v[60:63], a[108:111], v[236:239]
  ds_read_b64_tr_b16 v[54:55], v10 offset:59392
  s_waitcnt lgkmcnt(8)
  v_mfma_f32_16x16x32_bf16 v[192:195], v[64:67], a[112:115], v[192:195]
  ds_read_b64_tr_b16 v[56:57], v8 offset:53248
  v_mfma_f32_16x16x32_bf16 v[196:199], v[64:67], a[116:119], v[196:199]
  ds_read_b64_tr_b16 v[58:59], v8 offset:55296
  s_add_u32 m0, s75, 12288
  s_add_u32 s99, s98, 131072
  buffer_load_dwordx4 v247, s[52:55], s99 offen offset:0 lds
  v_mfma_f32_16x16x32_bf16 v[200:203], v[68:71], a[112:115], v[200:203]
  ds_read_b64_tr_b16 v[60:61], v8 offset:61440
  v_mfma_f32_16x16x32_bf16 v[204:207], v[68:71], a[116:119], v[204:207]
  ds_read_b64_tr_b16 v[62:63], v8 offset:63488
  s_waitcnt lgkmcnt(8)
  v_mfma_f32_16x16x32_bf16 v[208:211], v[72:75], a[112:115], v[208:211]
  ds_read_b64_tr_b16 v[64:65], v9 offset:53248
  v_mfma_f32_16x16x32_bf16 v[212:215], v[72:75], a[116:119], v[212:215]
  ds_read_b64_tr_b16 v[66:67], v9 offset:55296
  buffer_load_dwordx4 v248, s[52:55], s99 offen offset:1024 lds
  v_mfma_f32_16x16x32_bf16 v[216:219], v[76:79], a[112:115], v[216:219]
  ds_read_b64_tr_b16 v[68:69], v9 offset:61440
  v_mfma_f32_16x16x32_bf16 v[220:223], v[76:79], a[116:119], v[220:223]
  ds_read_b64_tr_b16 v[70:71], v9 offset:63488
  s_waitcnt lgkmcnt(8)
  v_mfma_f32_16x16x32_bf16 v[224:227], v[48:51], a[112:115], v[224:227]
  ds_read_b64_tr_b16 v[72:73], v10 offset:53248
  v_mfma_f32_16x16x32_bf16 v[228:231], v[48:51], a[116:119], v[228:231]
  ds_read_b64_tr_b16 v[74:75], v10 offset:55296
  buffer_load_dwordx4 v249, s[52:55], s99 offen offset:2048 lds
  v_mfma_f32_16x16x32_bf16 v[232:235], v[52:55], a[112:115], v[232:235]
  ds_read_b64_tr_b16 v[76:77], v10 offset:61440
  v_mfma_f32_16x16x32_bf16 v[236:239], v[52:55], a[116:119], v[236:239]
  ds_read_b64_tr_b16 v[78:79], v10 offset:63488
  s_waitcnt lgkmcnt(8)
  v_mfma_f32_16x16x32_bf16 v[192:195], v[56:59], a[120:123], v[192:195]
  v_mfma_f32_16x16x32_bf16 v[196:199], v[56:59], a[124:127], v[196:199]
  buffer_load_dwordx4 v250, s[52:55], s99 offen offset:3072 lds
  v_mfma_f32_16x16x32_bf16 v[200:203], v[60:63], a[120:123], v[200:203]
  v_mfma_f32_16x16x32_bf16 v[204:207], v[60:63], a[124:127], v[204:207]
  s_waitcnt lgkmcnt(4)
  v_mfma_f32_16x16x32_bf16 v[208:211], v[64:67], a[120:123], v[208:211]
  v_mfma_f32_16x16x32_bf16 v[212:215], v[64:67], a[124:127], v[212:215]
  v_mfma_f32_16x16x32_bf16 v[216:219], v[68:71], a[120:123], v[216:219]
  v_mfma_f32_16x16x32_bf16 v[220:223], v[68:71], a[124:127], v[220:223]
  s_waitcnt lgkmcnt(0)
  v_mfma_f32_16x16x32_bf16 v[224:227], v[72:75], a[120:123], v[224:227]
  v_mfma_f32_16x16x32_bf16 v[228:231], v[72:75], a[124:127], v[228:231]
  v_mfma_f32_16x16x32_bf16 v[232:235], v[76:79], a[120:123], v[232:235]
  v_mfma_f32_16x16x32_bf16 v[236:239], v[76:79], a[124:127], v[236:239]
  s_mov_b32 s58, 0xbfb8aa3b
  v_pk_mul_f32 v[36:37], v[192:193], s[58:59] op_sel_hi:[1,0]
  v_pk_mul_f32 v[38:39], v[194:195], s[58:59] op_sel_hi:[1,0]
  v_pk_mul_f32 v[40:41], v[196:197], s[58:59] op_sel_hi:[1,0]
  v_pk_mul_f32 v[42:43], v[198:199], s[58:59] op_sel_hi:[1,0]
  v_exp_f32 v36, v36
  v_exp_f32 v37, v37
  v_exp_f32 v38, v38
  v_exp_f32 v39, v39
  v_exp_f32 v40, v40
  v_exp_f32 v41, v41
  v_exp_f32 v42, v42
  v_exp_f32 v43, v43
  v_pk_mul_f32 v[192:193], v[192:193], v[200:201]
  v_pk_mul_f32 v[194:195], v[194:195], v[202:203]
  v_pk_mul_f32 v[196:197], v[196:197], v[204:205]
  v_pk_mul_f32 v[198:199], v[198:199], v[206:207]
  v_pk_add_f32 v[36:37], v[36:37], 1.0 op_sel_hi:[1,0]
  v_pk_add_f32 v[38:39], v[38:39], 1.0 op_sel_hi:[1,0]
  v_pk_add_f32 v[40:41], v[40:41], 1.0 op_sel_hi:[1,0]
  v_pk_add_f32 v[42:43], v[42:43], 1.0 op_sel_hi:[1,0]
  v_rcp_f32 v36, v36
  v_rcp_f32 v37, v37
  v_rcp_f32 v38, v38
  v_rcp_f32 v39, v39
  v_rcp_f32 v40, v40
  v_rcp_f32 v41, v41
  v_rcp_f32 v42, v42
  v_rcp_f32 v43, v43
  v_pk_mul_f32 v[192:193], v[192:193], v[36:37]
  v_pk_mul_f32 v[194:195], v[194:195], v[38:39]
  v_pk_mul_f32 v[196:197], v[196:197], v[40:41]
  v_pk_mul_f32 v[198:199], v[198:199], v[42:43]
  v_cvt_pk_bf16_f32 v104, v192, v193
  v_cvt_pk_bf16_f32 v105, v194, v195
  v_cvt_pk_bf16_f32 v106, v196, v197
  v_cvt_pk_bf16_f32 v107, v198, v199
  s_nop 0
  v_permlane16_swap_b32 v104, v106
  v_permlane16_swap_b32 v105, v107
  s_add_u32 s57, s73, 0
  buffer_store_dwordx4 v[104:107], v3, s[4:7], s57 offen sc1
  v_pk_mul_f32 v[36:37], v[208:209], s[58:59] op_sel_hi:[1,0]
  v_pk_mul_f32 v[38:39], v[210:211], s[58:59] op_sel_hi:[1,0]
  v_pk_mul_f32 v[40:41], v[212:213], s[58:59] op_sel_hi:[1,0]
  v_pk_mul_f32 v[42:43], v[214:215], s[58:59] op_sel_hi:[1,0]
  v_exp_f32 v36, v36
  v_exp_f32 v37, v37
  v_exp_f32 v38, v38
  v_exp_f32 v39, v39
  v_exp_f32 v40, v40
  v_exp_f32 v41, v41
  v_exp_f32 v42, v42
  v_exp_f32 v43, v43
  v_pk_mul_f32 v[208:209], v[208:209], v[216:217]
  v_pk_mul_f32 v[210:211], v[210:211], v[218:219]
  v_pk_mul_f32 v[212:213], v[212:213], v[220:221]
  v_pk_mul_f32 v[214:215], v[214:215], v[222:223]
  v_pk_add_f32 v[36:37], v[36:37], 1.0 op_sel_hi:[1,0]
  v_pk_add_f32 v[38:39], v[38:39], 1.0 op_sel_hi:[1,0]
  v_pk_add_f32 v[40:41], v[40:41], 1.0 op_sel_hi:[1,0]
  v_pk_add_f32 v[42:43], v[42:43], 1.0 op_sel_hi:[1,0]
  v_rcp_f32 v36, v36
  v_rcp_f32 v37, v37
  v_rcp_f32 v38, v38
  v_rcp_f32 v39, v39
  v_rcp_f32 v40, v40
  v_rcp_f32 v41, v41
  v_rcp_f32 v42, v42
  v_rcp_f32 v43, v43
  v_pk_mul_f32 v[208:209], v[208:209], v[36:37]
  v_pk_mul_f32 v[210:211], v[210:211], v[38:39]
  v_pk_mul_f32 v[212:213], v[212:213], v[40:41]
  v_pk_mul_f32 v[214:215], v[214:215], v[42:43]
  v_cvt_pk_bf16_f32 v108, v208, v209
  v_cvt_pk_bf16_f32 v109, v210, v211
  v_cvt_pk_bf16_f32 v110, v212, v213
  v_cvt_pk_bf16_f32 v111, v214, v215
  s_nop 0
  v_permlane16_swap_b32 v108, v110
  v_permlane16_swap_b32 v109, v111
  s_add_u32 s57, s73, 512
  buffer_store_dwordx4 v[108:111], v3, s[4:7], s57 offen sc1
  v_pk_mul_f32 v[36:37], v[224:225], s[58:59] op_sel_hi:[1,0]
  v_pk_mul_f32 v[38:39], v[226:227], s[58:59] op_sel_hi:[1,0]
  v_pk_mul_f32 v[40:41], v[228:229], s[58:59] op_sel_hi:[1,0]
  v_pk_mul_f32 v[42:43], v[230:231], s[58:59] op_sel_hi:[1,0]
  v_exp_f32 v36, v36
  v_exp_f32 v37, v37
  v_exp_f32 v38, v38
  v_exp_f32 v39, v39
  v_exp_f32 v40, v40
  v_exp_f32 v41, v41
  v_exp_f32 v42, v42
  v_exp_f32 v43, v43
  v_pk_mul_f32 v[224:225], v[224:225], v[232:233]
  v_pk_mul_f32 v[226:227], v[226:227], v[234:235]
  v_pk_mul_f32 v[228:229], v[228:229], v[236:237]
  v_pk_mul_f32 v[230:231], v[230:231], v[238:239]
  v_pk_add_f32 v[36:37], v[36:37], 1.0 op_sel_hi:[1,0]
  v_pk_add_f32 v[38:39], v[38:39], 1.0 op_sel_hi:[1,0]
  v_pk_add_f32 v[40:41], v[40:41], 1.0 op_sel_hi:[1,0]
  v_pk_add_f32 v[42:43], v[42:43], 1.0 op_sel_hi:[1,0]
  v_rcp_f32 v36, v36
  v_rcp_f32 v37, v37
  v_rcp_f32 v38, v38
  v_rcp_f32 v39, v39
  v_rcp_f32 v40, v40
  v_rcp_f32 v41, v41
  v_rcp_f32 v42, v42
  v_rcp_f32 v43, v43
  v_pk_mul_f32 v[224:225], v[224:225], v[36:37]
  v_pk_mul_f32 v[226:227], v[226:227], v[38:39]
  v_pk_mul_f32 v[228:229], v[228:229], v[40:41]
  v_pk_mul_f32 v[230:231], v[230:231], v[42:43]
  v_cvt_pk_bf16_f32 v104, v224, v225
  v_cvt_pk_bf16_f32 v105, v226, v227
  v_cvt_pk_bf16_f32 v106, v228, v229
  v_cvt_pk_bf16_f32 v107, v230, v231
  s_nop 0
  v_permlane16_swap_b32 v104, v106
  v_permlane16_swap_b32 v105, v107
  s_add_u32 s57, s73, 1024
  buffer_store_dwordx4 v[104:107], v3, s[4:7], s57 offen sc1
  s_lshr_b32 s70, s46, 3
  s_and_b32 s71, s46, 7
  s_add_u32 s8, s42, 0x880000
  s_addc_u32 s9, s43, 0
  s_mov_b32 s10, 0x700000
  s_mov_b32 s11, 0x20000
  s_mul_i32 s56, s70, 229376
  s_lshl_b32 s76, s3, 13
  s_mul_i32 s77, s3, 6144
  s_add_u32 s77, s77, 32768
  v_lshlrev_b32 v9, 4, v1
  v_add_u32 v9, s56, v9
  v_add_u32 v10, 57344, v9
  v_add_u32 v11, 57344, v10
  v_add_u32 v12, 57344, v11
  s_add_u32 s101, s76, 0
  buffer_load_dwordx4 v[16:19], v9, s[8:11], s101 offen offset:0 sc1
  buffer_load_dwordx4 v[20:23], v10, s[8:11], s101 offen offset:0 sc1
  buffer_load_dwordx4 v[24:27], v11, s[8:11], s101 offen offset:0 sc1
  buffer_load_dwordx4 v[28:31], v12, s[8:11], s101 offen offset:0 sc1
  buffer_load_dwordx4 v[32:35], v9, s[8:11], s101 offen offset:1024 sc1
  buffer_load_dwordx4 v[36:39], v10, s[8:11], s101 offen offset:1024 sc1
  buffer_load_dwordx4 v[40:43], v11, s[8:11], s101 offen offset:1024 sc1
  buffer_load_dwordx4 v[44:47], v12, s[8:11], s101 offen offset:1024 sc1
  buffer_load_dwordx4 v[48:51], v9, s[8:11], s101 offen offset:2048 sc1
  buffer_load_dwordx4 v[52:55], v10, s[8:11], s101 offen offset:2048 sc1
  buffer_load_dwordx4 v[56:59], v11, s[8:11], s101 offen offset:2048 sc1
  buffer_load_dwordx4 v[60:63], v12, s[8:11], s101 offen offset:2048 sc1
  s_waitcnt vmcnt(12)
  s_waitcnt lgkmcnt(0)
  s_barrier
  s_cmp_lg_u32 s3, 0
  s_cbranch_scc1 X4B_S
  s_lshl_b32 s57, s47, 7
  s_lshl_b32 s56, s63, 2
  s_add_u32 s57, s57, s56
  s_add_u32 s57, s57, 16384
  v_mov_b32 v4, 0x40000000
  v_mov_b32 v5, 1
  v_writelane_b32 v4, s57, 0
  buffer_store_dword v5, v4, s[80:83], 0 offen sc1
X4B_S:
  s_add_u32 m0, s74, 0
  s_add_u32 s99, s98, 163840
  buffer_load_dwordx4 v247, s[52:55], s99 offen offset:0 lds
  buffer_load_dwordx4 v248, s[52:55], s99 offen offset:1024 lds
  buffer_load_dwordx4 v249, s[52:55], s99 offen offset:2048 lds
  buffer_load_dwordx4 v250, s[52:55], s99 offen offset:3072 lds
  s_add_u32 s4, s42, 0x480000
  s_addc_u32 s5, s43, 0
  s_mov_b32 s6, 0x200000
  s_mov_b32 s7, 0x20000
  s_add_u32 s12, s42, 0xf80000
  s_addc_u32 s13, s43, 0
  s_mov_b32 s14, 0x3000
  s_mov_b32 s15, 0x20000
  s_lshl_b32 s56, s70, 6
  s_lshl_b32 s57, s3, 4
  s_add_u32 s56, s56, s57
  s_lshl_b32 s56, s56, 10
  s_lshl_b32 s57, s71, 7
  s_add_u32 s56, s56, s57
  v_lshrrev_b32 v4, 2, v1
  v_lshlrev_b32 v4, 10, v4
  v_and_b32 v5, 3, v1
  v_lshl_add_u32 v4, v5, 5, v4
  v_add_u32 v4, s56, v4
  s_lshl_b32 s57, s71, 8
  s_add_u32 s57, s57, 10240
  v_lshlrev_b32 v6, 6, v5
  v_add_u32 v6, s57, v6
  s_lshr_b32 s57, s46, 4
  s_lshl_b32 s57, s57, 7
  s_add_u32 s57, s57, 16384
  s_cmp_eq_u32 s3, 0
  s_cselect_b32 s57, s57, 0x40000000
  v_and_b32 v13, 15, v1
  v_lshlrev_b32 v13, 2, v13
  v_add_u32 v13, s57, v13
  s_sub_u32 s56, s60, s61
  v_add_u32 v234, s56, v251
  v_add_u32 v235, s56, v252
  v_add_u32 v236, s56, v253
  v_add_u32 v237, s56, v254
  s_sub_u32 s56, s74, s61
  v_add_u32 v240, s56, v251
  v_add_u32 v241, s56, v252
  v_add_u32 v242, s56, v253
  v_add_u32 v243, s56, v254
  s_sub_u32 s56, s75, s61
  v_add_u32 v244, s56, v251
  v_add_u32 v245, s56, v252
  v_add_u32 v246, s56, v253
  v_add_u32 v247, s56, v254
  s_waitcnt vmcnt(12)
  v_mfma_f32_16x16x32_bf16 v[128:131], a[128:131], v[16:19], 0
  buffer_load_dwordx4 v[64:67], v9, s[8:11], s101 offen offset:3072 sc1
  v_mfma_f32_16x16x32_bf16 v[132:135], a[128:131], v[20:23], 0
  buffer_load_dwordx4 v[68:71], v10, s[8:11], s101 offen offset:3072 sc1
  ds_read_b64_tr_b16 a[240:241], v234 offset:0
  v_mfma_f32_16x16x32_bf16 v[136:139], a[128:131], v[24:27], 0
  buffer_load_dwordx4 v[72:75], v11, s[8:11], s101 offen offset:3072 sc1
  v_mfma_f32_16x16x32_bf16 v[140:143], a[128:131], v[28:31], 0
  buffer_load_dwordx4 v[76:79], v12, s[8:11], s101 offen offset:3072 sc1
  ds_read_b64_tr_b16 a[242:243], v234 offset:512
  v_mfma_f32_16x16x32_bf16 v[144:147], a[132:135], v[16:19], 0
  s_add_u32 s101, s76, 4096
  buffer_load_dwordx4 v[80:83], v9, s[8:11], s101 offen offset:0 sc1
  v_mfma_f32_16x16x32_bf16 v[148:151], a[132:135], v[20:23], 0
  buffer_load_dwordx4 v[84:87], v10, s[8:11], s101 offen offset:0 sc1
  ds_read_b64_tr_b16 a[244:245], v235 offset:0
  v_mfma_f32_16x16x32_bf16 v[152:155], a[132:135], v[24:27], 0
  buffer_load_dwordx4 v[88:91], v11, s[8:11], s101 offen offset:0 sc1
  v_mfma_f32_16x16x32_bf16 v[156:159], a[132:135], v[28:31], 0
  buffer_load_dwordx4 v[92:95], v12, s[8:11], s101 offen offset:0 sc1
  ds_read_b64_tr_b16 a[246:247], v235 offset:512
  v_mfma_f32_16x16x32_bf16 v[160:163], a[136:139], v[16:19], 0
  buffer_load_dwordx4 v[96:99], v9, s[8:11], s101 offen offset:1024 sc1
  v_mfma_f32_16x16x32_bf16 v[164:167], a[136:139], v[20:23], 0
  ds_read_b64_tr_b16 a[248:249], v236 offset:0
  v_mfma_f32_16x16x32_bf16 v[168:171], a[136:139], v[24:27], 0
  buffer_load_dwordx4 v[100:103], v10, s[8:11], s101 offen offset:1024 sc1
  v_mfma_f32_16x16x32_bf16 v[172:175], a[136:139], v[28:31], 0
  ds_read_b64_tr_b16 a[250:251], v236 offset:512
  v_mfma_f32_16x16x32_bf16 v[176:179], a[140:143], v[16:19], 0
  buffer_load_dwordx4 v[104:107], v11, s[8:11], s101 offen offset:1024 sc1
  v_mfma_f32_16x16x32_bf16 v[180:183], a[140:143], v[20:23], 0
  ds_read_b64_tr_b16 a[252:253], v237 offset:0
  v_mfma_f32_16x16x32_bf16 v[184:187], a[140:143], v[24:27], 0
  buffer_load_dwordx4 v[108:111], v12, s[8:11], s101 offen offset:1024 sc1
  v_mfma_f32_16x16x32_bf16 v[188:191], a[140:143], v[28:31], 0
  ds_read_b64_tr_b16 a[254:255], v237 offset:512
  s_waitcnt vmcnt(20)
  v_mfma_f32_16x16x32_bf16 v[128:131], a[144:147], v[32:35], v[128:131]
  buffer_load_dwordx4 v[112:115], v9, s[8:11], s101 offen offset:2048 sc1
  v_mfma_f32_16x16x32_bf16 v[132:135], a[144:147], v[36:39], v[132:135]
  ds_read_b64_tr_b16 a[0:1], v234 offset:4096
  v_mfma_f32_16x16x32_bf16 v[136:139], a[144:147], v[40:43], v[136:139]
  buffer_load_dwordx4 v[116:119], v10, s[8:11], s101 offen offset:2048 sc1
  v_mfma_f32_16x16x32_bf16 v[140:143], a[144:147], v[44:47], v[140:143]
  ds_read_b64_tr_b16 a[2:3], v234 offset:4608
  v_mfma_f32_16x16x32_bf16 v[144:147], a[148:151], v[32:35], v[144:147]
  buffer_load_dwordx4 v[120:123], v11, s[8:11], s101 offen offset:2048 sc1
  v_mfma_f32_16x16x32_bf16 v[148:151], a[148:151], v[36:39], v[148:151]
  ds_read_b64_tr_b16 a[4:5], v235 offset:4096
  v_mfma_f32_16x16x32_bf16 v[152:155], a[148:151], v[40:43], v[152:155]
  buffer_load_dwordx4 v[124:127], v12, s[8:11], s101 offen offset:2048 sc1
  v_mfma_f32_16x16x32_bf16 v[156:159], a[148:151], v[44:47], v[156:159]
  ds_read_b64_tr_b16 a[6:7], v235 offset:4608
  v_mfma_f32_16x16x32_bf16 v[160:163], a[152:155], v[32:35], v[160:163]
  buffer_load_dwordx4 v[16:19], v9, s[8:11], s101 offen offset:3072 sc1
  v_mfma_f32_16x16x32_bf16 v[164:167], a[152:155], v[36:39], v[164:167]
  ds_read_b64_tr_b16 a[8:9], v236 offset:4096
  v_mfma_f32_16x16x32_bf16 v[168:171], a[152:155], v[40:43], v[168:171]
  buffer_load_dwordx4 v[20:23], v10, s[8:11], s101 offen offset:3072 sc1
  v_mfma_f32_16x16x32_bf16 v[172:175], a[152:155], v[44:47], v[172:175]
  ds_read_b64_tr_b16 a[10:11], v236 offset:4608
  v_mfma_f32_16x16x32_bf16 v[176:179], a[156:159], v[32:35], v[176:179]
  buffer_load_dwordx4 v[24:27], v11, s[8:11], s101 offen offset:3072 sc1
  v_mfma_f32_16x16x32_bf16 v[180:183], a[156:159], v[36:39], v[180:183]
  ds_read_b64_tr_b16 a[12:13], v237 offset:4096
  v_mfma_f32_16x16x32_bf16 v[184:187], a[156:159], v[40:43], v[184:187]
  buffer_load_dwordx4 v[28:31], v12, s[8:11], s101 offen offset:3072 sc1
  v_mfma_f32_16x16x32_bf16 v[188:191], a[156:159], v[44:47], v[188:191]
  ds_read_b64_tr_b16 a[14:15], v237 offset:4608
  s_waitcnt vmcnt(24)
  v_mfma_f32_16x16x32_bf16 v[128:131], a[160:163], v[48:51], v[128:131]
  v_mfma_f32_16x16x32_bf16 v[132:135], a[160:163], v[52:55], v[132:135]
  ds_read_b64_tr_b16 a[16:17], v244 offset:0
  v_mfma_f32_16x16x32_bf16 v[136:139], a[160:163], v[56:59], v[136:139]
  v_mfma_f32_16x16x32_bf16 v[140:143], a[160:163], v[60:63], v[140:143]
  ds_read_b64_tr_b16 a[18:19], v244 offset:512
  v_mfma_f32_16x16x32_bf16 v[144:147], a[164:167], v[48:51], v[144:147]
  v_mfma_f32_16x16x32_bf16 v[148:151], a[164:167], v[52:55], v[148:151]
  ds_read_b64_tr_b16 a[20:21], v245 offset:0
  v_mfma_f32_16x16x32_bf16 v[152:155], a[164:167], v[56:59], v[152:155]
  v_mfma_f32_16x16x32_bf16 v[156:159], a[164:167], v[60:63], v[156:159]
  ds_read_b64_tr_b16 a[22:23], v245 offset:512
  v_mfma_f32_16x16x32_bf16 v[160:163], a[168:171], v[48:51], v[160:163]
  v_mfma_f32_16x16x32_bf16 v[164:167], a[168:171], v[52:55], v[164:167]
  ds_read_b64_tr_b16 a[24:25], v246 offset:0
  v_mfma_f32_16x16x32_bf16 v[168:171], a[168:171], v[56:59], v[168:171]
  v_mfma_f32_16x16x32_bf16 v[172:175], a[168:171], v[60:63], v[172:175]
  ds_read_b64_tr_b16 a[26:27], v246 offset:512
  v_mfma_f32_16x16x32_bf16 v[176:179], a[172:175], v[48:51], v[176:179]
  v_mfma_f32_16x16x32_bf16 v[180:183], a[172:175], v[52:55], v[180:183]
  ds_read_b64_tr_b16 a[28:29], v247 offset:0
  v_mfma_f32_16x16x32_bf16 v[184:187], a[172:175], v[56:59], v[184:187]
  v_mfma_f32_16x16x32_bf16 v[188:191], a[172:175], v[60:63], v[188:191]
  ds_read_b64_tr_b16 a[30:31], v247 offset:512
  s_waitcnt vmcnt(16)
  v_mfma_f32_16x16x32_bf16 v[128:131], a[176:179], v[64:67], v[128:131]
  buffer_load_dword v232, v13, s[80:83], 0 offen sc1
  v_mfma_f32_16x16x32_bf16 v[132:135], a[176:179], v[68:71], v[132:135]
  ds_read_b64_tr_b16 a[32:33], v244 offset:4096
  v_mfma_f32_16x16x32_bf16 v[136:139], a[176:179], v[72:75], v[136:139]
  v_mfma_f32_16x16x32_bf16 v[140:143], a[176:179], v[76:79], v[140:143]
  ds_read_b64_tr_b16 a[34:35], v244 offset:4608
  v_mfma_f32_16x16x32_bf16 v[144:147], a[180:183], v[64:67], v[144:147]
  v_mfma_f32_16x16x32_bf16 v[148:151], a[180:183], v[68:71], v[148:151]
  ds_read_b64_tr_b16 a[36:37], v245 offset:4096
  v_mfma_f32_16x16x32_bf16 v[152:155], a[180:183], v[72:75], v[152:155]
  v_mfma_f32_16x16x32_bf16 v[156:159], a[180:183], v[76:79], v[156:159]
  ds_read_b64_tr_b16 a[38:39], v245 offset:4608
  v_mfma_f32_16x16x32_bf16 v[160:163], a[184:187], v[64:67], v[160:163]
  v_mfma_f32_16x16x32_bf16 v[164:167], a[184:187], v[68:71], v[164:167]
  ds_read_b64_tr_b16 a[40:41], v246 offset:4096
  v_mfma_f32_16x16x32_bf16 v[168:171], a[184:187], v[72:75], v[168:171]
  v_mfma_f32_16x16x32_bf16 v[172:175], a[184:187], v[76:79], v[172:175]
  ds_read_b64_tr_b16 a[42:43], v246 offset:4608
  v_mfma_f32_16x16x32_bf16 v[176:179], a[188:191], v[64:67], v[176:179]
  v_mfma_f32_16x16x32_bf16 v[180:183], a[188:191], v[68:71], v[180:183]
  ds_read_b64_tr_b16 a[44:45], v247 offset:4096
  v_mfma_f32_16x16x32_bf16 v[184:187], a[188:191], v[72:75], v[184:187]
  v_mfma_f32_16x16x32_bf16 v[188:191], a[188:191], v[76:79], v[188:191]
  ds_read_b64_tr_b16 a[46:47], v247 offset:4608
  s_waitcnt vmcnt(13)
  v_mfma_f32_16x16x32_bf16 v[128:131], a[192:195], v[80:83], v[128:131]
  v_mfma_f32_16x16x32_bf16 v[132:135], a[192:195], v[84:87], v[132:135]
  ds_read_b64_tr_b16 a[48:49], v244 offset:8192
  v_mfma_f32_16x16x32_bf16 v[136:139], a[192:195], v[88:91], v[136:139]
  v_mfma_f32_16x16x32_bf16 v[140:143], a[192:195], v[92:95], v[140:143]
  ds_read_b64_tr_b16 a[50:51], v244 offset:8704
  v_mfma_f32_16x16x32_bf16 v[144:147], a[196:199], v[80:83], v[144:147]
  v_mfma_f32_16x16x32_bf16 v[148:151], a[196:199], v[84:87], v[148:151]
  ds_read_b64_tr_b16 a[52:53], v245 offset:8192
  v_mfma_f32_16x16x32_bf16 v[152:155], a[196:199], v[88:91], v[152:155]
  v_mfma_f32_16x16x32_bf16 v[156:159], a[196:199], v[92:95], v[156:159]
  ds_read_b64_tr_b16 a[54:55], v245 offset:8704
  v_mfma_f32_16x16x32_bf16 v[160:163], a[200:203], v[80:83], v[160:163]
  v_mfma_f32_16x16x32_bf16 v[164:167], a[200:203], v[84:87], v[164:167]
  ds_read_b64_tr_b16 a[56:57], v246 offset:8192
  v_mfma_f32_16x16x32_bf16 v[168:171], a[200:203], v[88:91], v[168:171]
  v_mfma_f32_16x16x32_bf16 v[172:175], a[200:203], v[92:95], v[172:175]
  ds_read_b64_tr_b16 a[58:59], v246 offset:8704
  v_mfma_f32_16x16x32_bf16 v[176:179], a[204:207], v[80:83], v[176:179]
  v_mfma_f32_16x16x32_bf16 v[180:183], a[204:207], v[84:87], v[180:183]
  ds_read_b64_tr_b16 a[60:61], v247 offset:8192
  v_mfma_f32_16x16x32_bf16 v[184:187], a[204:207], v[88:91], v[184:187]
  v_mfma_f32_16x16x32_bf16 v[188:191], a[204:207], v[92:95], v[188:191]
  ds_read_b64_tr_b16 a[62:63], v247 offset:8704
  s_waitcnt vmcnt(0)
  s_cmp_lg_u32 s3, 0
  s_cbranch_scc1 X4B_OK
  v_cmp_gt_u32 vcc, 1, v232
  s_nop 3
  s_cbranch_vccz X4B_OK
  s_mov_b32 s56, 0
  buffer_load_dword v232, v13, s[80:83], 0 offen sc1
POLL11:
  buffer_load_dword v233, v13, s[80:83], 0 offen sc1
  s_waitcnt vmcnt(1)
  v_cmp_gt_u32 vcc, 1, v232
  s_nop 3
  s_cbranch_vccz POLLD12
  buffer_load_dword v232, v13, s[80:83], 0 offen sc1
  s_waitcnt vmcnt(1)
  v_cmp_gt_u32 vcc, 1, v233
  s_nop 3
  s_cbranch_vccz POLLD12
  s_add_u32 s56, s56, 1
  s_cmp_lt_u32 s56, 400000
  s_cbranch_scc1 POLL11
POLLD12:
  s_waitcnt vmcnt(0)
X4B_OK:
  s_barrier
  v_mfma_f32_16x16x32_bf16 v[128:131], a[208:211], v[96:99], v[128:131]
  s_add_u32 s101, s77, 0
  buffer_load_dwordx4 v[32:35], v9, s[8:11], s101 offen offset:0 sc1
  v_mfma_f32_16x16x32_bf16 v[132:135], a[208:211], v[100:103], v[132:135]
  buffer_load_dwordx4 v[36:39], v10, s[8:11], s101 offen offset:0 sc1
  ds_read_b64_tr_b16 a[64:65], v244 offset:12288
  v_mfma_f32_16x16x32_bf16 v[136:139], a[208:211], v[104:107], v[136:139]
  buffer_load_dwordx4 v[40:43], v11, s[8:11], s101 offen offset:0 sc1
  v_mfma_f32_16x16x32_bf16 v[140:143], a[208:211], v[108:111], v[140:143]
  buffer_load_dwordx4 v[44:47], v12, s[8:11], s101 offen offset:0 sc1
  ds_read_b64_tr_b16 a[66:67], v244 offset:12800
  v_mfma_f32_16x16x32_bf16 v[144:147], a[212:215], v[96:99], v[144:147]
  buffer_load_dwordx4 v[48:51], v9, s[8:11], s101 offen offset:1024 sc1
  v_mfma_f32_16x16x32_bf16 v[148:151], a[212:215], v[100:103], v[148:151]
  buffer_load_dwordx4 v[52:55], v10, s[8:11], s101 offen offset:1024 sc1
  ds_read_b64_tr_b16 a[68:69], v245 offset:12288
  v_mfma_f32_16x16x32_bf16 v[152:155], a[212:215], v[104:107], v[152:155]
  buffer_load_dwordx4 v[56:59], v11, s[8:11], s101 offen offset:1024 sc1
  v_mfma_f32_16x16x32_bf16 v[156:159], a[212:215], v[108:111], v[156:159]
  buffer_load_dwordx4 v[60:63], v12, s[8:11], s101 offen offset:1024 sc1
  ds_read_b64_tr_b16 a[70:71], v245 offset:12800
  v_mfma_f32_16x16x32_bf16 v[160:163], a[216:219], v[96:99], v[160:163]
  buffer_load_dwordx4 v[64:67], v9, s[8:11], s101 offen offset:2048 sc1
  v_mfma_f32_16x16x32_bf16 v[164:167], a[216:219], v[100:103], v[164:167]
  ds_read_b64_tr_b16 a[72:73], v246 offset:12288
  v_mfma_f32_16x16x32_bf16 v[168:171], a[216:219], v[104:107], v[168:171]
  buffer_load_dwordx4 v[68:71], v10, s[8:11], s101 offen offset:2048 sc1
  v_mfma_f32_16x16x32_bf16 v[172:175], a[216:219], v[108:111], v[172:175]
  ds_read_b64_tr_b16 a[74:75], v246 offset:12800
  v_mfma_f32_16x16x32_bf16 v[176:179], a[220:223], v[96:99], v[176:179]
  buffer_load_dwordx4 v[72:75], v11, s[8:11], s101 offen offset:2048 sc1
  v_mfma_f32_16x16x32_bf16 v[180:183], a[220:223], v[100:103], v[180:183]
  ds_read_b64_tr_b16 a[76:77], v247 offset:12288
  v_mfma_f32_16x16x32_bf16 v[184:187], a[220:223], v[104:107], v[184:187]
  buffer_load_dwordx4 v[76:79], v12, s[8:11], s101 offen offset:2048 sc1
  v_mfma_f32_16x16x32_bf16 v[188:191], a[220:223], v[108:111], v[188:191]
  ds_read_b64_tr_b16 a[78:79], v247 offset:12800
  v_mfma_f32_16x16x32_bf16 v[128:131], a[224:227], v[112:115], v[128:131]
  buffer_load_dwordx4 v[80:83], v9, s[8:11], s101 offen offset:3072 sc1
  v_mfma_f32_16x16x32_bf16 v[132:135], a[224:227], v[116:119], v[132:135]
  ds_read_b64_tr_b16 a[80:81], v240 offset:0
  v_mfma_f32_16x16x32_bf16 v[136:139], a[224:227], v[120:123], v[136:139]
  buffer_load_dwordx4 v[84:87], v10, s[8:11], s101 offen offset:3072 sc1
  v_mfma_f32_16x16x32_bf16 v[140:143], a[224:227], v[124:127], v[140:143]
  ds_read_b64_tr_b16 a[82:83], v240 offset:512
  v_mfma_f32_16x16x32_bf16 v[144:147], a[228:231], v[112:115], v[144:147]
  buffer_load_dwordx4 v[88:91], v11, s[8:11], s101 offen offset:3072 sc1
  v_mfma_f32_16x16x32_bf16 v[148:151], a[228:231], v[116:119], v[148:151]
  ds_read_b64_tr_b16 a[84:85], v241 offset:0
  v_mfma_f32_16x16x32_bf16 v[152:155], a[228:231], v[120:123], v[152:155]
  buffer_load_dwordx4 v[92:95], v12, s[8:11], s101 offen offset:3072 sc1
  v_mfma_f32_16x16x32_bf16 v[156:159], a[228:231], v[124:127], v[156:159]
  ds_read_b64_tr_b16 a[86:87], v241 offset:512
  v_mfma_f32_16x16x32_bf16 v[160:163], a[232:235], v[112:115], v[160:163]
  s_add_u32 s101, s77, 4096
  buffer_load_dwordx4 v[96:99], v9, s[8:11], s101 offen offset:0 sc1
  v_mfma_f32_16x16x32_bf16 v[164:167], a[232:235], v[116:119], v[164:167]
  ds_read_b64_tr_b16 a[88:89], v242 offset:0
  v_mfma_f32_16x16x32_bf16 v[168:171], a[232:235], v[120:123], v[168:171]
  buffer_load_dwordx4 v[100:103], v10, s[8:11], s101 offen offset:0 sc1
  v_mfma_f32_16x16x32_bf16 v[172:175], a[232:235], v[124:127], v[172:175]
  ds_read_b64_tr_b16 a[90:91], v242 offset:512
  v_mfma_f32_16x16x32_bf16 v[176:179], a[236:239], v[112:115], v[176:179]
  buffer_load_dwordx4 v[104:107], v11, s[8:11], s101 offen offset:0 sc1
  v_mfma_f32_16x16x32_bf16 v[180:183], a[236:239], v[116:119], v[180:183]
  ds_read_b64_tr_b16 a[92:93], v243 offset:0
  v_mfma_f32_16x16x32_bf16 v[184:187], a[236:239], v[120:123], v[184:187]
  buffer_load_dwordx4 v[108:111], v12, s[8:11], s101 offen offset:0 sc1
  v_mfma_f32_16x16x32_bf16 v[188:191], a[236:239], v[124:127], v[188:191]
  ds_read_b64_tr_b16 a[94:95], v243 offset:512
  s_waitcnt lgkmcnt(0)
  v_mfma_f32_16x16x32_bf16 v[128:131], a[240:243], v[16:19], v[128:131]
  buffer_load_dwordx4 v[112:115], v9, s[8:11], s101 offen offset:1024 sc1
  v_mfma_f32_16x16x32_bf16 v[132:135], a[240:243], v[20:23], v[132:135]
  v_mfma_f32_16x16x32_bf16 v[136:139], a[240:243], v[24:27], v[136:139]
  buffer_load_dwordx4 v[116:119], v10, s[8:11], s101 offen offset:1024 sc1
  v_mfma_f32_16x16x32_bf16 v[140:143], a[240:243], v[28:31], v[140:143]
  v_mfma_f32_16x16x32_bf16 v[144:147], a[244:247], v[16:19], v[144:147]
  buffer_load_dwordx4 v[120:123], v11, s[8:11], s101 offen offset:1024 sc1
  v_mfma_f32_16x16x32_bf16 v[148:151], a[244:247], v[20:23], v[148:151]
  v_mfma_f32_16x16x32_bf16 v[152:155], a[244:247], v[24:27], v[152:155]
  buffer_load_dwordx4 v[124:127], v12, s[8:11], s101 offen offset:1024 sc1
  v_mfma_f32_16x16x32_bf16 v[156:159], a[244:247], v[28:31], v[156:159]
  v_mfma_f32_16x16x32_bf16 v[160:163], a[248:251], v[16:19], v[160:163]
  v_mfma_f32_16x16x32_bf16 v[164:167], a[248:251], v[20:23], v[164:167]
  v_mfma_f32_16x16x32_bf16 v[168:171], a[248:251], v[24:27], v[168:171]
  v_mfma_f32_16x16x32_bf16 v[172:175], a[248:251], v[28:31], v[172:175]
  v_mfma_f32_16x16x32_bf16 v[176:179], a[252:255], v[16:19], v[176:179]
  v_mfma_f32_16x16x32_bf16 v[180:183], a[252:255], v[20:23], v[180:183]
  v_mfma_f32_16x16x32_bf16 v[184:187], a[252:255], v[24:27], v[184:187]
  v_mfma_f32_16x16x32_bf16 v[188:191], a[252:255], v[28:31], v[188:191]
  s_waitcnt vmcnt(20)
  v_mfma_f32_16x16x32_bf16 v[128:131], a[0:3], v[32:35], v[128:131]
  v_mfma_f32_16x16x32_bf16 v[132:135], a[0:3], v[36:39], v[132:135]
  v_mfma_f32_16x16x32_bf16 v[136:139], a[0:3], v[40:43], v[136:139]
  v_mfma_f32_16x16x32_bf16 v[140:143], a[0:3], v[44:47], v[140:143]
  v_mfma_f32_16x16x32_bf16 v[144:147], a[4:7], v[32:35], v[144:147]
  v_mfma_f32_16x16x32_bf16 v[148:151], a[4:7], v[36:39], v[148:151]
  v_mfma_f32_16x16x32_bf16 v[152:155], a[4:7], v[40:43], v[152:155]
  v_mfma_f32_16x16x32_bf16 v[156:159], a[4:7], v[44:47], v[156:159]
  v_mfma_f32_16x16x32_bf16 v[160:163], a[8:11], v[32:35], v[160:163]
  v_mfma_f32_16x16x32_bf16 v[164:167], a[8:11], v[36:39], v[164:167]
  v_mfma_f32_16x16x32_bf16 v[168:171], a[8:11], v[40:43], v[168:171]
  v_mfma_f32_16x16x32_bf16 v[172:175], a[8:11], v[44:47], v[172:175]
  v_mfma_f32_16x16x32_bf16 v[176:179], a[12:15], v[32:35], v[176:179]
  v_mfma_f32_16x16x32_bf16 v[180:183], a[12:15], v[36:39], v[180:183]
  v_mfma_f32_16x16x32_bf16 v[184:187], a[12:15], v[40:43], v[184:187]
  v_mfma_f32_16x16x32_bf16 v[188:191], a[12:15], v[44:47], v[188:191]
  s_waitcnt vmcnt(16)
  v_mfma_f32_16x16x32_bf16 v[128:131], a[16:19], v[48:51], v[128:131]
  buffer_load_dwordx4 v[192:195], v4, s[4:7], 0 offen sc1
  v_mfma_f32_16x16x32_bf16 v[132:135], a[16:19], v[52:55], v[132:135]
  v_mfma_f32_16x16x32_bf16 v[136:139], a[16:19], v[56:59], v[136:139]
  buffer_load_dwordx4 v[196:199], v4, s[4:7], 0 offen offset:16 sc1
  v_mfma_f32_16x16x32_bf16 v[140:143], a[16:19], v[60:63], v[140:143]
  v_mfma_f32_16x16x32_bf16 v[144:147], a[20:23], v[48:51], v[144:147]
  buffer_load_dwordx4 v[200:203], v6, s[12:15], 0 offen offset:0 sc1
  v_mfma_f32_16x16x32_bf16 v[148:151], a[20:23], v[52:55], v[148:151]
  v_mfma_f32_16x16x32_bf16 v[152:155], a[20:23], v[56:59], v[152:155]
  buffer_load_dwordx4 v[204:207], v6, s[12:15], 0 offen offset:16 sc1
  v_mfma_f32_16x16x32_bf16 v[156:159], a[20:23], v[60:63], v[156:159]
  v_mfma_f32_16x16x32_bf16 v[160:163], a[24:27], v[48:51], v[160:163]
  buffer_load_dwordx4 v[208:211], v6, s[12:15], 0 offen offset:32 sc1
  v_mfma_f32_16x16x32_bf16 v[164:167], a[24:27], v[52:55], v[164:167]
  v_mfma_f32_16x16x32_bf16 v[168:171], a[24:27], v[56:59], v[168:171]
  buffer_load_dwordx4 v[212:215], v6, s[12:15], 0 offen offset:48 sc1
  v_mfma_f32_16x16x32_bf16 v[172:175], a[24:27], v[60:63], v[172:175]
  v_mfma_f32_16x16x32_bf16 v[176:179], a[28:31], v[48:51], v[176:179]
  v_mfma_f32_16x16x32_bf16 v[180:183], a[28:31], v[52:55], v[180:183]
  v_mfma_f32_16x16x32_bf16 v[184:187], a[28:31], v[56:59], v[184:187]
  v_mfma_f32_16x16x32_bf16 v[188:191], a[28:31], v[60:63], v[188:191]
  s_waitcnt vmcnt(18)
  v_mfma_f32_16x16x32_bf16 v[128:131], a[32:35], v[64:67], v[128:131]
  v_mfma_f32_16x16x32_bf16 v[132:135], a[32:35], v[68:71], v[132:135]
  v_mfma_f32_16x16x32_bf16 v[136:139], a[32:35], v[72:75], v[136:139]
  v_mfma_f32_16x16x32_bf16 v[140:143], a[32:35], v[76:79], v[140:143]
  v_mfma_f32_16x16x32_bf16 v[144:147], a[36:39], v[64:67], v[144:147]
  v_mfma_f32_16x16x32_bf16 v[148:151], a[36:39], v[68:71], v[148:151]
  v_mfma_f32_16x16x32_bf16 v[152:155], a[36:39], v[72:75], v[152:155]
  v_mfma_f32_16x16x32_bf16 v[156:159], a[36:39], v[76:79], v[156:159]
  v_mfma_f32_16x16x32_bf16 v[160:163], a[40:43], v[64:67], v[160:163]
  v_mfma_f32_16x16x32_bf16 v[164:167], a[40:43], v[68:71], v[164:167]
  v_mfma_f32_16x16x32_bf16 v[168:171], a[40:43], v[72:75], v[168:171]
  v_mfma_f32_16x16x32_bf16 v[172:175], a[40:43], v[76:79], v[172:175]
  v_mfma_f32_16x16x32_bf16 v[176:179], a[44:47], v[64:67], v[176:179]
  v_mfma_f32_16x16x32_bf16 v[180:183], a[44:47], v[68:71], v[180:183]
  v_mfma_f32_16x16x32_bf16 v[184:187], a[44:47], v[72:75], v[184:187]
  v_mfma_f32_16x16x32_bf16 v[188:191], a[44:47], v[76:79], v[188:191]
  s_waitcnt vmcnt(14)
  v_mfma_f32_16x16x32_bf16 v[128:131], a[48:51], v[80:83], v[128:131]
  v_mfma_f32_16x16x32_bf16 v[132:135], a[48:51], v[84:87], v[132:135]
  v_mfma_f32_16x16x32_bf16 v[136:139], a[48:51], v[88:91], v[136:139]
  v_mfma_f32_16x16x32_bf16 v[140:143], a[48:51], v[92:95], v[140:143]
  v_mfma_f32_16x16x32_bf16 v[144:147], a[52:55], v[80:83], v[144:147]
  v_mfma_f32_16x16x32_bf16 v[148:151], a[52:55], v[84:87], v[148:151]
  v_mfma_f32_16x16x32_bf16 v[152:155], a[52:55], v[88:91], v[152:155]
  v_mfma_f32_16x16x32_bf16 v[156:159], a[52:55], v[92:95], v[156:159]
  v_mfma_f32_16x16x32_bf16 v[160:163], a[56:59], v[80:83], v[160:163]
  v_mfma_f32_16x16x32_bf16 v[164:167], a[56:59], v[84:87], v[164:167]
  v_mfma_f32_16x16x32_bf16 v[168:171], a[56:59], v[88:91], v[168:171]
  v_mfma_f32_16x16x32_bf16 v[172:175], a[56:59], v[92:95], v[172:175]
  v_mfma_f32_16x16x32_bf16 v[176:179], a[60:63], v[80:83], v[176:179]
  v_mfma_f32_16x16x32_bf16 v[180:183], a[60:63], v[84:87], v[180:183]
  v_mfma_f32_16x16x32_bf16 v[184:187], a[60:63], v[88:91], v[184:187]
  v_mfma_f32_16x16x32_bf16 v[188:191], a[60:63], v[92:95], v[188:191]
  s_waitcnt vmcnt(10)
  v_mfma_f32_16x16x32_bf16 v[128:131], a[64:67], v[96:99], v[128:131]
  v_mfma_f32_16x16x32_bf16 v[132:135], a[64:67], v[100:103], v[132:135]
  v_mfma_f32_16x16x32_bf16 v[136:139], a[64:67], v[104:107], v[136:139]
  v_mfma_f32_16x16x32_bf16 v[140:143], a[64:67], v[108:111], v[140:143]
  v_mfma_f32_16x16x32_bf16 v[144:147], a[68:71], v[96:99], v[144:147]
  v_mfma_f32_16x16x32_bf16 v[148:151], a[68:71], v[100:103], v[148:151]
  v_mfma_f32_16x16x32_bf16 v[152:155], a[68:71], v[104:107], v[152:155]
  v_mfma_f32_16x16x32_bf16 v[156:159], a[68:71], v[108:111], v[156:159]
  v_mfma_f32_16x16x32_bf16 v[160:163], a[72:75], v[96:99], v[160:163]
  v_mfma_f32_16x16x32_bf16 v[164:167], a[72:75], v[100:103], v[164:167]
  v_mfma_f32_16x16x32_bf16 v[168:171], a[72:75], v[104:107], v[168:171]
  v_mfma_f32_16x16x32_bf16 v[172:175], a[72:75], v[108:111], v[172:175]
  v_mfma_f32_16x16x32_bf16 v[176:179], a[76:79], v[96:99], v[176:179]
  v_mfma_f32_16x16x32_bf16 v[180:183], a[76:79], v[100:103], v[180:183]
  v_mfma_f32_16x16x32_bf16 v[184:187], a[76:79], v[104:107], v[184:187]
  v_mfma_f32_16x16x32_bf16 v[188:191], a[76:79], v[108:111], v[188:191]
  s_waitcnt vmcnt(6)
  v_mfma_f32_16x16x32_bf16 v[128:131], a[80:83], v[112:115], v[128:131]
  v_mfma_f32_16x16x32_bf16 v[132:135], a[80:83], v[116:119], v[132:135]
  v_mfma_f32_16x16x32_bf16 v[136:139], a[80:83], v[120:123], v[136:139]
  v_mfma_f32_16x16x32_bf16 v[140:143], a[80:83], v[124:127], v[140:143]
  v_mfma_f32_16x16x32_bf16 v[144:147], a[84:87], v[112:115], v[144:147]
  v_mfma_f32_16x16x32_bf16 v[148:151], a[84:87], v[116:119], v[148:151]
  v_mfma_f32_16x16x32_bf16 v[152:155], a[84:87], v[120:123], v[152:155]
  v_mfma_f32_16x16x32_bf16 v[156:159], a[84:87], v[124:127], v[156:159]
  v_mfma_f32_16x16x32_bf16 v[160:163], a[88:91], v[112:115], v[160:163]
  v_mfma_f32_16x16x32_bf16 v[164:167], a[88:91], v[116:119], v[164:167]
  v_mfma_f32_16x16x32_bf16 v[168:171], a[88:91], v[120:123], v[168:171]
  v_mfma_f32_16x16x32_bf16 v[172:175], a[88:91], v[124:127], v[172:175]
  v_mfma_f32_16x16x32_bf16 v[176:179], a[92:95], v[112:115], v[176:179]
  v_mfma_f32_16x16x32_bf16 v[180:183], a[92:95], v[116:119], v[180:183]
  v_mfma_f32_16x16x32_bf16 v[184:187], a[92:95], v[120:123], v[184:187]
  v_mfma_f32_16x16x32_bf16 v[188:191], a[92:95], v[124:127], v[188:191]
  v_lshlrev_b32 v3, 4, v1
  v_add_u32 v3, s61, v3
  ds_write_b128 v3, v[128:131] offset:0
  ds_write_b128 v3, v[144:147] offset:1088
  ds_write_b128 v3, v[160:163] offset:2176
  ds_write_b128 v3, v[176:179] offset:3264
  ds_write_b128 v3, v[132:135] offset:4352
  ds_write_b128 v3, v[148:151] offset:5440
  ds_write_b128 v3, v[164:167] offset:6528
  ds_write_b128 v3, v[180:183] offset:7616
  ds_write_b128 v3, v[136:139] offset:8704
  ds_write_b128 v3, v[152:155] offset:9792
  ds_write_b128 v3, v[168:171] offset:10880
  ds_write_b128 v3, v[184:187] offset:11968
  ds_write_b128 v3, v[140:143] offset:13056
  ds_write_b128 v3, v[156:159] offset:14144
  ds_write_b128 v3, v[172:175] offset:15232
  ds_write_b128 v3, v[188:191] offset:16320
  s_waitcnt vmcnt(0)
  v_cvt_pk_bf16_f32 v200, 0, v200
  v_cvt_pk_bf16_f32 v201, 0, v201
  v_cvt_pk_bf16_f32 v202, 0, v202
  v_cvt_pk_bf16_f32 v203, 0, v203
  v_cvt_pk_bf16_f32 v204, 0, v204
  v_cvt_pk_bf16_f32 v205, 0, v205
  v_cvt_pk_bf16_f32 v206, 0, v206
  v_cvt_pk_bf16_f32 v207, 0, v207
  v_cvt_pk_bf16_f32 v208, 0, v208
  v_cvt_pk_bf16_f32 v209, 0, v209
  v_cvt_pk_bf16_f32 v210, 0, v210
  v_cvt_pk_bf16_f32 v211, 0, v211
  v_cvt_pk_bf16_f32 v212, 0, v212
  v_cvt_pk_bf16_f32 v213, 0, v213
  v_cvt_pk_bf16_f32 v214, 0, v214
  v_cvt_pk_bf16_f32 v215, 0, v215
  v_lshlrev_b32 v216, 16, v192
  v_and_b32 v217, 0xffff0000, v192
  v_lshlrev_b32 v218, 16, v193
  v_and_b32 v219, 0xffff0000, v193
  v_lshlrev_b32 v220, 16, v194
  v_and_b32 v221, 0xffff0000, v194
  v_lshlrev_b32 v222, 16, v195
  v_and_b32 v223, 0xffff0000, v195
  v_lshlrev_b32 v224, 16, v196
  v_and_b32 v225, 0xffff0000, v196
  v_lshlrev_b32 v226, 16, v197
  v_and_b32 v227, 0xffff0000, v197
  v_lshlrev_b32 v228, 16, v198
  v_and_b32 v229, 0xffff0000, v198
  v_lshlrev_b32 v230, 16, v199
  v_and_b32 v231, 0xffff0000, v199
  s_mov_b32 s12, s38
  s_mov_b32 s13, s39
  s_mov_b32 s14, 0x200000
  s_mov_b32 s15, 0x20000
  v_lshrrev_b32 v7, 2, v1
  v_lshlrev_b32 v7, 4, v7
  v_mul_u32_u24 v3, 1088, v5
  v_add_u32 v7, v7, v3
  s_mul_i32 s57, s3, 4352
  v_add_u32 v7, s57, v7
  v_add_u32 v3, 57856, v7
  s_waitcnt lgkmcnt(0)
  s_barrier
  ds_read_b128 v[64:67], v7 offset:0
  ds_read_b128 v[68:71], v7 offset:256
  ds_read_b128 v[72:75], v7 offset:512
  ds_read_b128 v[76:79], v7 offset:768
  ds_read_b128 v[80:83], v7 offset:28928
  ds_read_b128 v[84:87], v7 offset:29184
  ds_read_b128 v[88:91], v7 offset:29440
  ds_read_b128 v[92:95], v7 offset:29696
  ds_read_b128 v[96:99], v3 offset:0
  ds_read_b128 v[100:103], v3 offset:256
  ds_read_b128 v[104:107], v3 offset:512
  ds_read_b128 v[108:111], v3 offset:768
  ds_read_b128 v[112:115], v3 offset:28928
  ds_read_b128 v[116:119], v3 offset:29184
  ds_read_b128 v[120:123], v3 offset:29440
  ds_read_b128 v[124:127], v3 offset:29696
  s_waitcnt lgkmcnt(0)
  v_pk_add_f32 v[64:65], v[64:65], v[80:81]
  v_pk_add_f32 v[96:97], v[96:97], v[112:113]
  v_pk_add_f32 v[66:67], v[66:67], v[82:83]
  v_pk_add_f32 v[98:99], v[98:99], v[114:115]
  v_pk_add_f32 v[68:69], v[68:69], v[84:85]
  v_pk_add_f32 v[100:101], v[100:101], v[116:117]
  v_pk_add_f32 v[70:71], v[70:71], v[86:87]
  v_pk_add_f32 v[102:103], v[102:103], v[118:119]
  v_pk_add_f32 v[72:73], v[72:73], v[88:89]
  v_pk_add_f32 v[104:105], v[104:105], v[120:121]
  v_pk_add_f32 v[74:75], v[74:75], v[90:91]
  v_pk_add_f32 v[106:107], v[106:107], v[122:123]
  v_pk_add_f32 v[76:77], v[76:77], v[92:93]
  v_pk_add_f32 v[108:109], v[108:109], v[124:125]
  v_pk_add_f32 v[78:79], v[78:79], v[94:95]
  v_pk_add_f32 v[110:111], v[110:111], v[126:127]
  v_pk_add_f32 v[64:65], v[64:65], v[96:97]
  v_pk_add_f32 v[66:67], v[66:67], v[98:99]
  v_pk_add_f32 v[68:69], v[68:69], v[100:101]
  v_pk_add_f32 v[70:71], v[70:71], v[102:103]
  v_pk_add_f32 v[72:73], v[72:73], v[104:105]
  v_pk_add_f32 v[74:75], v[74:75], v[106:107]
  v_pk_add_f32 v[76:77], v[76:77], v[108:109]
  v_pk_add_f32 v[78:79], v[78:79], v[110:111]
  v_cvt_pk_bf16_f32 v64, 0, v64
  v_cvt_pk_bf16_f32 v65, 0, v65
  v_cvt_pk_bf16_f32 v66, 0, v66
  v_cvt_pk_bf16_f32 v67, 0, v67
  v_cvt_pk_bf16_f32 v68, 0, v68
  v_cvt_pk_bf16_f32 v69, 0, v69
  v_cvt_pk_bf16_f32 v70, 0, v70
  v_cvt_pk_bf16_f32 v71, 0, v71
  v_cvt_pk_bf16_f32 v72, 0, v72
  v_cvt_pk_bf16_f32 v73, 0, v73
  v_cvt_pk_bf16_f32 v74, 0, v74
  v_cvt_pk_bf16_f32 v75, 0, v75
  v_cvt_pk_bf16_f32 v76, 0, v76
  v_cvt_pk_bf16_f32 v77, 0, v77
  v_cvt_pk_bf16_f32 v78, 0, v78
  v_cvt_pk_bf16_f32 v79, 0, v79
  v_pk_mul_f32 v[64:65], v[64:65], v[200:201]
  v_pk_mul_f32 v[66:67], v[66:67], v[202:203]
  v_pk_mul_f32 v[68:69], v[68:69], v[204:205]
  v_pk_mul_f32 v[70:71], v[70:71], v[206:207]
  v_pk_mul_f32 v[72:73], v[72:73], v[208:209]
  v_pk_mul_f32 v[74:75], v[74:75], v[210:211]
  v_pk_mul_f32 v[76:77], v[76:77], v[212:213]
  v_pk_mul_f32 v[78:79], v[78:79], v[214:215]
  v_cvt_pk_bf16_f32 v64, 0, v64
  v_cvt_pk_bf16_f32 v65, 0, v65
  v_cvt_pk_bf16_f32 v66, 0, v66
  v_cvt_pk_bf16_f32 v67, 0, v67
  v_cvt_pk_bf16_f32 v68, 0, v68
  v_cvt_pk_bf16_f32 v69, 0, v69
  v_cvt_pk_bf16_f32 v70, 0, v70
  v_cvt_pk_bf16_f32 v71, 0, v71
  v_cvt_pk_bf16_f32 v72, 0, v72
  v_cvt_pk_bf16_f32 v73, 0, v73
  v_cvt_pk_bf16_f32 v74, 0, v74
  v_cvt_pk_bf16_f32 v75, 0, v75
  v_cvt_pk_bf16_f32 v76, 0, v76
  v_cvt_pk_bf16_f32 v77, 0, v77
  v_cvt_pk_bf16_f32 v78, 0, v78
  v_cvt_pk_bf16_f32 v79, 0, v79
  v_pk_add_f32 v[64:65], v[64:65], v[216:217]
  v_pk_add_f32 v[66:67], v[66:67], v[218:219]
  v_pk_add_f32 v[68:69], v[68:69], v[220:221]
  v_pk_add_f32 v[70:71], v[70:71], v[222:223]
  v_pk_add_f32 v[72:73], v[72:73], v[224:225]
  v_pk_add_f32 v[74:75], v[74:75], v[226:227]
  v_pk_add_f32 v[76:77], v[76:77], v[228:229]
  v_pk_add_f32 v[78:79], v[78:79], v[230:231]
  v_cvt_pk_bf16_f32 v40, v64, v65
  v_cvt_pk_bf16_f32 v41, v66, v67
  v_cvt_pk_bf16_f32 v42, v68, v69
  v_cvt_pk_bf16_f32 v43, v70, v71
  v_cvt_pk_bf16_f32 v44, v72, v73
  v_cvt_pk_bf16_f32 v45, v74, v75
  v_cvt_pk_bf16_f32 v46, v76, v77
  v_cvt_pk_bf16_f32 v47, v78, v79
  buffer_store_dwordx4 v[40:43], v4, s[12:15], 0 offen
  buffer_store_dwordx4 v[44:47], v4, s[12:15], 0 offen offset:16
K_END:
  s_endpgm
K_CODE_END:
.section .rodata,"a"
.p2align 6
.amdhsa_kernel adaLN_cond__ssm_conv_h3__swiglu_ffn__prompt_kernel
  .amdhsa_next_free_vgpr 512
  .amdhsa_next_free_sgpr 102
  .amdhsa_accum_offset 256
  .amdhsa_group_segment_fixed_size 0
  .amdhsa_kernarg_size 120
  .amdhsa_user_sgpr_count 2
  .amdhsa_user_sgpr_kernarg_segment_ptr 1
  .amdhsa_system_sgpr_workgroup_id_x 1
  .amdhsa_float_denorm_mode_32 3
.end_amdhsa_kernel
```
